```python
import torch

def _softmax(x, axis=-1):
    return torch.softmax(x, dim=axis)
def _gelu(x):
    return torch.nn.functional.gelu(x, approximate="tanh")
def _silu(x):
    return torch.nn.functional.silu(x)
def _sigmoid(x):
    return torch.sigmoid(x)
def _layernorm(x, axis=-1, eps=1e-5):
    m = x.mean(dim=axis, keepdim=True)
    v = x.var(dim=axis, keepdim=True, unbiased=False)
    return (x - m) / torch.sqrt(v + eps)
def _scatter_add(tgt, idx, src, axis=0):
    return tgt.clone().index_add_(axis, idx, src)
def _segment_sum(src, seg, n):
    out = torch.zeros((n,) + src.shape[1:], dtype=src.dtype)
    return out.index_add_(0, seg, src)
def _pad(x, pw):
    flat = tuple(v for pair in reversed(pw) for v in pair)
    return torch.nn.functional.pad(x, flat)

kernel_name = 'parallel_sum__ssm_conv_h3__dense_activation_silu__prompt'

def setup_inputs():

    _w = (lambda a: (lambda t: t.to(torch.bfloat16) if t.is_floating_point() else t)(torch.as_tensor(a)))
    def _A_setup():
        B, S, D = 1, 2048, 512
        ks = 4
        return {
            "q": _w((lambda *s: torch.randn(*s, dtype=torch.bfloat16) * 0.05)(B, S, D)),
            "k": _w((lambda *s: torch.randn(*s, dtype=torch.bfloat16) * 0.2)(B, S, D)),
            "v": _w((lambda *s: torch.randn(*s, dtype=torch.bfloat16) * 0.2)(B, S, D)),
            "shift_k": _w((lambda *s: torch.randn(*s, dtype=torch.bfloat16) * 0.2)(D, ks) * 0.5),
            "ssm_k": _w((lambda *s: torch.randn(*s, dtype=torch.bfloat16) * 0.8)(D, S) * (1.0 / S ** 0.5)),
            "ssm_D": _w((lambda *s: torch.randn(*s, dtype=torch.bfloat16) * 0.2)(D)),
        }
    _A_in = _A_setup()

    def _B_setup():
        B, S, D, F = 1, 2048, 512, 1376
        return {
            "x": _w((lambda *s: torch.randn(*s, dtype=torch.bfloat16) * 0.05)(B, S, D)),
            "w1": _w((lambda *s: torch.randn(*s, dtype=torch.bfloat16) * 0.8)(D, F) * (D ** -0.5)),
            "w2": _w((lambda *s: torch.randn(*s, dtype=torch.bfloat16) * 0.1)(F, D) * (F ** -0.5)),
        }
    _B_in = _B_setup()

    return {
        "A_q": _A_in["q"],
        "A_k": _A_in["k"],
        "A_v": _A_in["v"],
        "A_shift_k": _A_in["shift_k"],
        "A_ssm_k": _A_in["ssm_k"],
        "A_ssm_D": _A_in["ssm_D"],
        "B_x": _B_in["x"],
        "B_w1": _B_in["w1"],
        "B_w2": _B_in["w2"],
    }

def reference(A_q, A_k, A_v, A_shift_k, A_ssm_k, A_ssm_D, B_x, B_w1, B_w2):
    def _A_ref(q, k, v, shift_k, ssm_k, ssm_D):
        B, S, D = q.shape
        ks = shift_k.shape[-1]
        k_pad = _pad(k, ((0, 0), (ks - 1, 0), (0, 0)))
        k_shift = torch.zeros_like(k)
        for t in range(ks):
            k_shift = k_shift + k_pad[:, t:t + S, :] * shift_k[:, ks - 1 - t][None, None, :]
        kv = k_shift * v
        L = 2 * S
        kv_pad = _pad(kv, ((0, 0), (0, S), (0, 0)))
        kf_pad = _pad(ssm_k, ((0, 0), (0, S)))
        kv_f = (lambda x, axes=(-2,-1): torch.fft.rfft2(x.float(), dim=axes))(kv_pad[:, None, :, :], axes=(1, 2))
        kf_f = (lambda x, axes=(-2,-1): torch.fft.rfft2(x.float(), dim=axes))(kf_pad[:, None, :], axes=(1, 2))
        kf_f = (lambda x, *d: x.permute(*d))(kf_f, 1, 2, 0)
        y_f = kv_f * kf_f[None, :, :, :]
        y = (lambda x, s, axes=(-2,-1): torch.fft.irfft2(x, s=s, dim=axes).to(torch.bfloat16))(y_f, (1, L), axes=(1, 2))[:, 0, :S, :]
        y = y + kv * ssm_D[None, None, :]
        return q * y

    def _B_ref(x, w1, w2):
        h = torch.einsum("bsd,df->bsf", x, w1)
        h = _silu(h)
        out = torch.einsum("bsf,fd->bsd", h, w2)
        return out

    x = A_q
    xn = _layernorm(x, axis=-1)
    return x + _A_ref(xn, A_k, A_v, A_shift_k, A_ssm_k, A_ssm_D) + _B_ref(xn, B_w1, B_w2)
```

```asm
; @launch grid=(256,1,1) block=(512,1,1) lds=163840
.amdgcn_target "amdgcn-amd-amdhsa--gfx950"
.text
.globl parallel_sum__ssm_conv_h3__dense_activation_silu__prompt_kernel
.p2align 8
.type parallel_sum__ssm_conv_h3__dense_activation_silu__prompt_kernel,@function
parallel_sum__ssm_conv_h3__dense_activation_silu__prompt_kernel:
    s_cmp_ge_u32 s2, 256
    s_cbranch_scc1 L_end
    s_load_dwordx16 s[76:91], s[0:1], 0
    s_load_dwordx8 s[92:99], s[0:1], 64
    v_lshrrev_b32 v3, 6, v0
    v_and_b32 v1, 63, v0
    s_getpc_b64 s[60:61]
L_pc:
    v_readfirstlane_b32 s50, v3
    s_lshr_b32 s75, s2, 3
    v_lshlrev_b32 v39, 7, v1
    s_and_b32 s62, s75, 7
    s_lshl_b32 s62, s62, 12
    s_cmp_ge_u32 s50, 4
    s_cselect_b32 s62, s62, 0
    s_lshl_b32 s63, s50, 10
    s_add_u32 s62, s62, s63
    v_add_u32 v3, s62, v39
    v_min_u32 v3, L_end-L_pc, v3
    s_mov_b64 exec, 0xff
    global_load_dword v254, v3, s[60:61]
    s_mov_b64 exec, -1
    s_and_b32 s49, s50, 3
    s_and_b32 s60, s2, 7
    s_lshr_b32 s44, s60, 0
    s_lshl_b32 s44, s44, 1
    s_and_b32 s61, s75, 1
    s_add_u32 s44, s44, s61
    s_and_b32 s45, s60, 0
    s_lshl_b32 s45, s45, 4
    s_lshr_b32 s61, s75, 1
    s_add_u32 s45, s45, s61
    s_and_b32 s61, s45, 1
    s_lshl_b32 s46, s44, 1
    s_add_u32 s46, s46, s61
    s_lshr_b32 s47, s45, 1
    s_xor_b32 s47, s47, 4
    s_lshl_b32 s74, s49, 11
    v_lshlrev_b32 v2, 4, v1
    s_cmp_ge_u32 s50, 4
    s_cbranch_scc1 L_compute
    s_mov_b32 s26, 1409024
    s_mov_b32 s27, 0x20000
    s_mov_b32 s6, 2097152
    s_mov_b32 s7, 0x20000
    s_mov_b32 s10, 2097152
    s_mov_b32 s11, 0x20000
    s_mov_b32 s14, 2097152
    s_mov_b32 s15, 0x20000
    s_mov_b32 s18, 4096
    s_mov_b32 s19, 0x20000
    v_min_u32 v15, 5376, v39
    v_lshrrev_b32 v33, 3, v1
    v_and_b32 v34, 7, v1
    v_lshlrev_b32 v33, 10, v33
    s_lshl_b32 s60, s46, 16
    s_lshl_b32 s61, s49, 14
    s_add_u32 s60, s60, s61
    s_lshl_b32 s61, s47, 7
    s_add_u32 s101, s60, s61
    v_lshrrev_b32 v35, 5, v1
    v_xor_b32 v35, v35, v34
    v_lshl_add_u32 v38, v35, 4, v33
    s_lshl_b32 s60, s49, 6
    s_and_b32 s60, s60, 64
    s_xor_b32 s61, s60, 32
    v_xor_b32 v12, s61, v38
    s_xor_b32 s61, s60, 64
    v_xor_b32 v13, s61, v38
    v_add_u32 v13, 8192, v13
    v_add_u32 v38, s101, v38
    v_subrev_u32 v14, 8192, v38
    s_lshl_b32 s54, s44, 17
    s_waitcnt lgkmcnt(0)
    s_mov_b64 s[24:25], s[90:91]
    s_mov_b64 s[4:5], s[76:77]
    s_mov_b64 s[8:9], s[78:79]
    s_mov_b64 s[12:13], s[80:81]
    s_mov_b64 s[16:17], s[82:83]
    s_cmp_ge_u32 s49, 2
    s_cbranch_scc1 L1
    s_cmp_lg_u32 s49, 0
    s_cbranch_scc1 L3
    s_mov_b32 m0, 114688
    s_nop 0
    buffer_load_dwordx4 v14, s[8:11], 0 offen lds
    s_branch L4
L3:
    s_lshl_b32 s60, s47, 9
    s_mov_b32 m0, 132096
    s_nop 0
    buffer_load_dwordx4 v2, s[16:19], s60 offen lds
    s_branch L4
L1:
L4:
    s_add_u32 m0, s74, 115712
    s_nop 0
    buffer_load_dwordx4 v12, s[8:11], s101 offen nt lds
    s_add_u32 m0, s74, 116736
    s_nop 0
    buffer_load_dwordx4 v13, s[8:11], s101 offen nt lds
    s_add_u32 m0, s74, 123904
    s_nop 0
    buffer_load_dwordx4 v12, s[12:15], s101 offen nt lds
    s_add_u32 m0, s74, 124928
    s_nop 0
    buffer_load_dwordx4 v13, s[12:15], s101 offen nt lds
    s_mov_b64 s[20:21], s[84:85]
    s_mov_b64 s[28:29], s[92:93]
    s_mov_b64 s[36:37], s[98:99]
    s_load_dword s43, s[36:37], 0
    s_lshl_b32 s48, s47, 5
    s_add_u32 s48, s48, s46
    s_lshl_b32 s63, s49, 12
    s_lshl_b32 s62, s49, 10
    s_and_b32 s71, s49, 1
    s_lshr_b32 s72, s49, 1
    s_mul_i32 s53, s45, 3
    s_lshl_b32 s60, s45, 1
    s_add_u32 s60, s60, 11
    s_min_u32 s53, s53, s60
    s_mov_b32 s38, 16777216
    s_mov_b32 s39, 0x20000
    v_mov_b32 v29, 162304
    s_lshl_b32 s60, s50, 2
    v_add_u32 v30, s60, v29
    s_lshl_b32 s60, s48, 2
    s_load_dword s42, s[86:87], s60
    v_lshrrev_b32 v32, 4, v1
    v_xor_b32 v35, v34, v32
    v_lshl_add_u32 v4, v35, 4, v33
    v_xor_b32 v5, 64, v4
    v_add_u32 v5, 8192, v5
    v_add_u32 v6, 16384, v4
    v_add_u32 v7, 16384, v5
    s_lshl_b32 s60, s49, 15
    s_add_u32 s54, s54, s60
    s_mul_i32 s64, s49, 3072
    s_cmp_lt_u32 s45, 11
    s_cselect_b32 s61, 12, 8
    v_mov_b32 v3, 2130706432
    v_mul_u32_u24 v37, 5462, v1
    v_lshrrev_b32 v37, 16, v37
    v_mul_u32_u24 v35, 12, v37
    v_sub_u32 v35, v1, v35
    v_cmp_gt_u32 vcc, s61, v35
    v_mul_u32_u24 v37, 2752, v37
    v_lshl_add_u32 v8, v35, 4, v37
    v_cndmask_b32 v8, v3, v8, vcc
    v_add_u32 v36, 64, v1
    v_mul_u32_u24 v37, 5462, v36
    v_lshrrev_b32 v37, 16, v37
    v_mul_u32_u24 v35, 12, v37
    v_sub_u32 v35, v36, v35
    v_cmp_gt_u32 vcc, s61, v35
    v_mul_u32_u24 v37, 2752, v37
    v_lshl_add_u32 v9, v35, 4, v37
    v_cndmask_b32 v9, v3, v9, vcc
    v_add_u32 v36, 128, v1
    v_mul_u32_u24 v37, 5462, v36
    v_lshrrev_b32 v37, 16, v37
    v_mul_u32_u24 v35, 12, v37
    v_sub_u32 v35, v36, v35
    v_cmp_gt_u32 vcc, s61, v35
    v_mul_u32_u24 v37, 2752, v37
    v_lshl_add_u32 v10, v35, 4, v37
    v_cndmask_b32 v10, v3, v10, vcc
    s_mul_i32 s55, s49, 44032
    s_lshl_b32 s60, s53, 6
    s_add_u32 s55, s55, s60
    s_lshr_b32 s94, s44, 1
    s_add_u32 s94, s94, s45
    s_mov_b32 s22, 2097152
    s_mov_b32 s23, 0x20000
    s_mov_b32 s30, 1409024
    s_mov_b32 s31, 0x20000
    s_add_u32 s95, s94, 0
    s_and_b32 s95, s95, 7
    s_mul_i32 s81, s95, 176128
    s_add_u32 s81, s81, s55
    s_lshl_b32 s80, s95, 7
    s_add_u32 s80, s80, s54
    s_add_u32 m0, s64, 16384
    s_nop 0
    buffer_load_dwordx4 v8, s[24:27], s81 offen lds
    s_add_u32 m0, s64, 17408
    s_nop 0
    buffer_load_dwordx4 v9, s[24:27], s81 offen lds
    s_add_u32 m0, s64, 18432
    s_nop 0
    buffer_load_dwordx4 v10, s[24:27], s81 offen lds
    s_add_u32 m0, s63, 0
    s_nop 0
    buffer_load_dwordx4 v4, s[4:7], s80 offen lds
    s_branch L_loader2
L_compute:
    s_setprio 1
    s_mov_b32 s73, 0xffff0000
    v_lshrrev_b32 v198, 4, v1
    v_lshrrev_b32 v200, 5, v1
    v_and_b32 v201, 15, v1
    v_and_b32 v206, 1, v198
    s_lshl_b32 s60, s49, 1
    v_add_u32 v207, s60, v200
    v_add_u32 v208, 1, v201
    v_and_b32 v208, 7, v208
    v_xor_b32 v208, v208, v207
    v_lshlrev_b32 v209, 9, v201
    v_lshl_add_u32 v209, v206, 3, v209
    v_add_u32 v209, 115328, v209
    v_lshl_add_u32 v212, v208, 4, v209
    v_add_u32 v208, 2, v201
    v_and_b32 v208, 7, v208
    v_xor_b32 v208, v208, v207
    v_lshl_add_u32 v213, v208, 4, v209
    s_lshl_b32 s60, s49, 7
    s_add_u32 s60, s60, 132096
    v_lshlrev_b32 v214, 5, v198
    v_add_u32 v214, s60, v214
    v_lshlrev_b32 v215, 14, v198
    v_lshl_add_u32 v215, v201, 4, v215
    s_lshl_b32 s48, s47, 5
    s_add_u32 s48, s48, s46
    s_lshl_b32 s63, s49, 12
    s_lshl_b32 s62, s49, 10
    s_and_b32 s71, s49, 1
    s_lshr_b32 s72, s49, 1
    s_mul_i32 s53, s45, 3
    s_lshl_b32 s60, s45, 1
    s_add_u32 s60, s60, 11
    s_min_u32 s53, s53, s60
    s_mov_b32 s38, 16777216
    s_mov_b32 s39, 0x20000
    v_mov_b32 v29, 162304
    s_lshl_b32 s60, s50, 2
    v_add_u32 v30, s60, v29
    s_lshl_b32 s60, s44, 2
    s_add_u32 s60, s60, s49
    s_mul_i32 s60, s60, 86
    s_lshl_b32 s61, s53, 1
    s_add_u32 s60, s60, s61
    s_lshl_b32 s60, s60, 10
    s_add_u32 s40, s60, 5242880
    s_lshl_b32 s60, s48, 8
    s_add_u32 s60, s60, 3145728
    s_cmp_eq_u32 s49, 1
    s_cselect_b32 s40, s60, s40
    s_cselect_b32 s41, 3, 1
    v_mul_u32_u24 v244, 2031616, v1
    s_lshl_b32 s60, s46, 16
    s_lshl_b32 s61, s47, 7
    s_add_u32 s61, s61, s60
    s_lshl_b32 s60, s48, 12
    s_cmp_eq_u32 s49, 2
    s_cselect_b32 s60, s61, s60
    v_mov_b32 v245, s60
    s_waitcnt lgkmcnt(0)
    s_mov_b64 s[32:33], s[94:95]
    s_mov_b64 s[36:37], s[98:99]
    s_mov_b32 exec_lo, s41
    s_mov_b32 exec_hi, 0
    buffer_load_dword v254, v244, s[36:39], s40 offen sc1
    s_mov_b64 exec, 1
    s_cmp_lg_u32 s49, 0
    s_cbranch_scc1 C1
    global_load_dword v254, v245, s[84:85]
C1:
    s_cmp_lg_u32 s49, 2
    s_cbranch_scc1 C2
    global_load_dword v254, v245, s[94:95] sc1
C2:
    s_cmp_lg_u32 s49, 3
    s_cbranch_scc1 C3
    global_load_dword v254, v245, s[92:93]
C3:
    s_mov_b64 exec, -1
    s_load_dword s43, s[36:37], 0
    s_lshl_b32 s60, s47, 18
    s_lshl_b32 s61, s46, 8
    s_add_u32 s60, s60, s61
    s_lshl_b32 s61, s49, 16
    s_add_u32 s60, s60, s61
    s_add_u32 s83, s60, 1048576
    s_add_u32 s86, s83, 8192
    s_mov_b32 s67, 0x3f803f80
    v_and_b32 v199, 31, v1
    v_and_b32 v202, 1, v1
    v_and_b32 v203, 3, v1
    v_bfe_u32 v204, v1, 2, 2
    v_bfe_u32 v207, v1, 1, 3
    v_xor_b32 v207, v207, v200
    v_lshlrev_b32 v207, 4, v207
    v_lshl_add_u32 v205, v199, 7, v207
    v_add_u32 v207, s63, v205
    v_lshl_add_u32 v208, v200, 3, v204
    v_mul_u32_u24 v208, 192, v208
    v_lshl_add_u32 v208, v206, 5, v208
    v_lshl_add_u32 v208, v203, 3, v208
    s_add_u32 s60, s49, 0
    s_and_b32 s60, s60, 3
    s_lshl_b32 s61, s60, 5
    v_xor_b32 v12, s61, v207
    s_mul_i32 s61, s60, 3072
    v_add_u32 v20, s61, v208
    s_add_u32 s60, s49, 1
    s_and_b32 s60, s60, 3
    s_lshl_b32 s61, s60, 5
    v_xor_b32 v13, s61, v207
    s_mul_i32 s61, s60, 3072
    v_add_u32 v21, s61, v208
    s_add_u32 s60, s49, 2
    s_and_b32 s60, s60, 3
    s_lshl_b32 s61, s60, 5
    v_xor_b32 v14, s61, v207
    s_mul_i32 s61, s60, 3072
    v_add_u32 v22, s61, v208
    s_add_u32 s60, s49, 3
    s_and_b32 s60, s60, 3
    s_lshl_b32 s61, s60, 5
    v_xor_b32 v15, s61, v207
    s_mul_i32 s61, s60, 3072
    v_add_u32 v23, s61, v208
    v_mov_b32 v160, 0
    v_mov_b32 v161, 0
    v_mov_b32 v162, 0
    v_mov_b32 v163, 0
    v_mov_b32 v164, 0
    v_mov_b32 v165, 0
    v_mov_b32 v166, 0
    s_waitcnt lgkmcnt(0)
    s_add_u32 s51, s43, 1
    s_not_b32 s52, s51
    v_mov_b32 v255, 0
    s_mov_b64 exec, 1
    ds_write_b32 v30, v255
    s_mov_b64 exec, -1
    v_add_u32 v16, 57344, v12
    v_add_u32 v24, 57344, v20
    v_add_u32 v17, 57344, v13
    v_add_u32 v25, 57344, v21
    v_add_u32 v18, 57344, v14
    v_add_u32 v26, 57344, v22
    v_add_u32 v19, 57344, v15
    v_add_u32 v27, 57344, v23
    v_mov_b32 v252, s51
    v_mov_b32 v253, s52
    s_lshl_b32 s60, s48, 7
    s_lshl_b32 s61, s49, 15
    s_add_u32 s60, s60, s61
    s_add_u32 s60, s60, 524288
    v_lshlrev_b32 v28, 3, v201
    v_add_u32 v28, s60, v28
    v_mov_b32 v252, s52
    s_mov_b32 s82, 131072
    s_mov_b64 exec, 0xffff
    buffer_store_dwordx2 v[252:253], v28, s[36:39], s82 offen sc1
    s_mov_b64 exec, -1
    v_mov_b32 v252, s51
    s_mov_b32 s34, 2097152
    s_mov_b32 s35, 0x20000
    s_mov_b32 s65, 0x05040100
    s_and_b32 s61, s46, 1
    s_lshl_b32 s61, s61, 1
    s_add_u32 s61, s61, s71
    s_lshl_b32 s61, s61, 8
    s_add_u32 s61, s61, 158208
    v_lshlrev_b32 v207, 3, v199
    v_add_u32 v226, s61, v207
    s_lshl_b32 s60, s49, 8
    s_add_u32 s60, s60, 158208
    v_add_u32 v11, s60, v207
    v_add_u32 v3, 159232, v2
    s_lshl_b32 s60, s49, 2
    v_add_u32 v8, s60, v3
    s_lshl_b32 s60, s44, 2
    s_add_u32 s60, s60, s49
    s_mul_i32 s60, s60, 86
    s_lshl_b32 s61, s53, 1
    s_add_u32 s60, s60, s61
    s_lshl_b32 s60, s60, 10
    s_add_u32 s56, s60, 5242880
    s_add_u32 s57, s56, 4096
    s_cmp_lt_u32 s45, 11
    s_cselect_b32 s57, s57, 2130706432
    s_cselect_b32 s85, 0xffff, 0
    s_mov_b32 s84, -1
    v_lshlrev_b32 v10, 7, v1
    s_mul_i32 s60, s72, 9216
    s_add_u32 s60, s60, 114944
    s_lshl_b32 s61, s71, 8
    s_sub_u32 s60, s60, s61
    v_mul_u32_u24 v216, 4640, v202
    v_lshrrev_b32 v207, 1, v201
    v_lshl_add_u32 v207, v207, 2, v198
    v_lshl_add_u32 v216, v207, 4, v216
    v_add_u32 v216, s60, v216
    v_xor_b32 v207, 1, v202
    v_mul_u32_u24 v217, 4228, v207
    v_lshl_add_u32 v217, v201, 2, v217
    v_lshlrev_b32 v207, 4, v198
    v_sub_u32 v217, v217, v207
    s_mul_i32 s60, s72, 8448
    s_add_u32 s61, s60, s61
    s_add_u32 s61, s61, 133172
    v_add_u32 v217, s61, v217
    s_lshl_b32 s60, s46, 1
    s_add_u32 s60, s60, s71
    s_mul_i32 s60, s60, 86
    s_mul_i32 s61, s72, 43
    s_add_u32 s60, s60, s61
    s_lshl_b32 s60, s60, 10
    s_add_u32 s59, s60, 5242880
    s_lshl_b32 s60, s49, 13
    s_add_u32 s60, s60, 114688
    v_add_u32 v219, s60, v2
    v_lshl_add_u32 v207, v200, 2, v204
    v_lshlrev_b32 v207, 7, v207
    v_bfe_u32 v208, v1, 3, 1
    v_lshl_add_u32 v207, v208, 6, v207
    v_lshl_add_u32 v207, v206, 5, v207
    v_lshl_add_u32 v207, v202, 4, v207
    v_bfe_u32 v208, v1, 1, 1
    v_lshl_add_u32 v207, v208, 3, v207
    s_lshl_b32 s60, s72, 6
    v_xor_b32 v207, s60, v207
    s_lshl_b32 s61, s72, 11
    v_add_u32 v234, s61, v207
    v_xor_b32 v235, 64, v234
    v_add_u32 v236, 61440, v234
    v_add_u32 v237, 61440, v235
    v_add_u32 v238, 122880, v234
    v_add_u32 v239, 122880, v235
    v_lshlrev_b32 v9, 10, v200
    v_bfe_u32 v208, v1, 1, 4
    v_lshl_add_u32 v9, v208, 4, v9
    v_lshl_add_u32 v9, v202, 2, v9
    s_lshl_b32 s61, s72, 12
    s_lshl_b32 s92, s71, 3
    s_add_u32 s61, s61, s92
    s_add_u32 s61, s61, 32768
    v_add_u32 v9, s61, v9
    v_xor_b32 v207, s60, v205
    s_lshl_b32 s61, s71, 12
    s_add_u32 s61, s61, 150016
    v_add_u32 v224, s61, v207
    v_xor_b32 v225, 32, v224
    s_add_u32 s61, s63, 49152
    v_add_u32 v222, s61, v2
    s_xor_b32 s61, s63, 8192
    s_add_u32 s61, s61, 49152
    v_add_u32 v223, s61, v2
    s_add_u32 s61, s74, 40960
    v_bfe_u32 v207, v1, 1, 2
    v_xor_b32 v207, v207, v200
    v_lshlrev_b32 v207, 4, v207
    v_lshl_add_u32 v207, v199, 6, v207
    v_add_u32 v227, s61, v207
    v_xor_b32 v228, 32, v227
    v_lshrrev_b32 v208, 2, v1
    v_bfe_u32 v207, v1, 3, 2
    v_xor_b32 v207, v207, v203
    v_lshlrev_b32 v207, 4, v207
    v_lshl_add_u32 v207, v208, 6, v207
    v_add_u32 v229, s61, v207
    v_lshlrev_b32 v208, 10, v208
    v_lshl_add_u32 v230, v203, 4, v208
    s_lshl_b32 s92, s46, 16
    s_lshl_b32 s61, s47, 7
    s_add_u32 s92, s92, s61
    s_lshl_b32 s61, s71, 15
    s_add_u32 s92, s92, s61
    s_add_u32 s92, s92, s60
    s_add_u32 s93, s92, 16384
    s_waitcnt lgkmcnt(0)
    s_barrier
    ds_read_b128 v[190:193], v214 offset:0
    ds_read_b128 v[194:197], v214 offset:16
    ds_read_b64 v[168:169], v212 offset:0
    ds_read_b64 v[170:171], v212 offset:128
    ds_read_b64 v[172:173], v212 offset:256
    ds_read_b64 v[174:175], v213 offset:384
    ds_read_b64 v[176:177], v213 offset:512
    ds_read_b64 v[178:179], v213 offset:640
    ds_read_b64 v[180:181], v213 offset:768
    ds_read_b64 v[182:183], v213 offset:8576
    ds_read_b64 v[184:185], v213 offset:8704
    ds_read_b64 v[186:187], v213 offset:8832
    ds_read_b64 v[188:189], v213 offset:8960
    s_waitcnt lgkmcnt(12)
    v_lshlrev_b32 v32, 16, v190
    v_and_b32 v34, s73, v190
    v_lshlrev_b32 v36, 16, v191
    v_and_b32 v38, s73, v191
    v_lshlrev_b32 v33, 16, v192
    v_and_b32 v35, s73, v192
    v_lshlrev_b32 v37, 16, v193
    v_and_b32 v39, s73, v193
    s_waitcnt lgkmcnt(11)
    v_lshlrev_b32 v40, 16, v194
    v_and_b32 v42, s73, v194
    v_lshlrev_b32 v44, 16, v195
    v_and_b32 v46, s73, v195
    v_lshlrev_b32 v41, 16, v196
    v_and_b32 v43, s73, v196
    v_lshlrev_b32 v45, 16, v197
    v_and_b32 v47, s73, v197
    s_waitcnt lgkmcnt(10)
    v_lshlrev_b32 v48, 16, v168
    v_and_b32 v49, s73, v168
    s_waitcnt lgkmcnt(9)
    v_lshlrev_b32 v52, 16, v170
    v_and_b32 v53, s73, v170
    s_waitcnt lgkmcnt(8)
    v_lshlrev_b32 v56, 16, v172
    v_and_b32 v57, s73, v172
    s_waitcnt lgkmcnt(7)
    v_lshlrev_b32 v60, 16, v174
    v_and_b32 v61, s73, v174
    s_waitcnt lgkmcnt(6)
    v_lshlrev_b32 v64, 16, v176
    v_and_b32 v65, s73, v176
    s_waitcnt lgkmcnt(5)
    v_lshlrev_b32 v68, 16, v178
    v_and_b32 v69, s73, v178
    s_waitcnt lgkmcnt(4)
    v_lshlrev_b32 v72, 16, v180
    v_and_b32 v73, s73, v180
    s_waitcnt lgkmcnt(3)
    v_lshlrev_b32 v76, 16, v182
    v_and_b32 v77, s73, v182
    s_waitcnt lgkmcnt(2)
    v_lshlrev_b32 v80, 16, v184
    v_and_b32 v81, s73, v184
    s_waitcnt lgkmcnt(1)
    v_lshlrev_b32 v84, 16, v186
    v_and_b32 v85, s73, v186
    s_waitcnt lgkmcnt(0)
    v_lshlrev_b32 v88, 16, v188
    v_and_b32 v89, s73, v188
    v_pk_mul_f32 v[92:93], v[48:49], v[38:39]
    v_pk_mul_f32 v[94:95], v[52:53], v[38:39]
    v_pk_mul_f32 v[96:97], v[56:57], v[38:39]
    v_pk_mul_f32 v[98:99], v[60:61], v[38:39]
    v_pk_fma_f32 v[92:93], v[52:53], v[36:37], v[92:93]
    v_pk_fma_f32 v[94:95], v[56:57], v[36:37], v[94:95]
    v_pk_fma_f32 v[96:97], v[60:61], v[36:37], v[96:97]
    v_pk_fma_f32 v[98:99], v[64:65], v[36:37], v[98:99]
    v_pk_fma_f32 v[92:93], v[56:57], v[34:35], v[92:93]
    v_pk_fma_f32 v[94:95], v[60:61], v[34:35], v[94:95]
    v_pk_fma_f32 v[96:97], v[64:65], v[34:35], v[96:97]
    v_pk_fma_f32 v[98:99], v[68:69], v[34:35], v[98:99]
    v_pk_fma_f32 v[92:93], v[60:61], v[32:33], v[92:93]
    v_pk_fma_f32 v[94:95], v[64:65], v[32:33], v[94:95]
    v_pk_fma_f32 v[96:97], v[68:69], v[32:33], v[96:97]
    v_pk_fma_f32 v[98:99], v[72:73], v[32:33], v[98:99]
    v_pk_mul_f32 v[92:93], v[92:93], v[76:77]
    v_pk_mul_f32 v[94:95], v[94:95], v[80:81]
    v_pk_mul_f32 v[96:97], v[96:97], v[84:85]
    v_pk_mul_f32 v[98:99], v[98:99], v[88:89]
    v_cvt_pk_bf16_f32 v240, v92, v93
    v_cvt_pk_bf16_f32 v241, v94, v95
    v_cvt_pk_bf16_f32 v242, v96, v97
    v_cvt_pk_bf16_f32 v243, v98, v99
    v_lshlrev_b32 v50, 16, v169
    v_and_b32 v51, s73, v169
    v_lshlrev_b32 v54, 16, v171
    v_and_b32 v55, s73, v171
    v_lshlrev_b32 v58, 16, v173
    v_and_b32 v59, s73, v173
    v_lshlrev_b32 v62, 16, v175
    v_and_b32 v63, s73, v175
    v_lshlrev_b32 v66, 16, v177
    v_and_b32 v67, s73, v177
    v_lshlrev_b32 v70, 16, v179
    v_and_b32 v71, s73, v179
    v_lshlrev_b32 v74, 16, v181
    v_and_b32 v75, s73, v181
    v_lshlrev_b32 v78, 16, v183
    v_and_b32 v79, s73, v183
    v_lshlrev_b32 v82, 16, v185
    v_and_b32 v83, s73, v185
    v_lshlrev_b32 v86, 16, v187
    v_and_b32 v87, s73, v187
    v_lshlrev_b32 v90, 16, v189
    v_and_b32 v91, s73, v189
    v_pk_mul_f32 v[92:93], v[50:51], v[46:47]
    v_pk_mul_f32 v[94:95], v[54:55], v[46:47]
    v_pk_mul_f32 v[96:97], v[58:59], v[46:47]
    v_pk_mul_f32 v[98:99], v[62:63], v[46:47]
    v_pk_fma_f32 v[92:93], v[54:55], v[44:45], v[92:93]
    v_pk_fma_f32 v[94:95], v[58:59], v[44:45], v[94:95]
    v_pk_fma_f32 v[96:97], v[62:63], v[44:45], v[96:97]
    v_pk_fma_f32 v[98:99], v[66:67], v[44:45], v[98:99]
    v_pk_fma_f32 v[92:93], v[58:59], v[42:43], v[92:93]
    v_pk_fma_f32 v[94:95], v[62:63], v[42:43], v[94:95]
    v_pk_fma_f32 v[96:97], v[66:67], v[42:43], v[96:97]
    v_pk_fma_f32 v[98:99], v[70:71], v[42:43], v[98:99]
    v_pk_fma_f32 v[92:93], v[62:63], v[40:41], v[92:93]
    v_pk_fma_f32 v[94:95], v[66:67], v[40:41], v[94:95]
    v_pk_fma_f32 v[96:97], v[70:71], v[40:41], v[96:97]
    v_pk_fma_f32 v[98:99], v[74:75], v[40:41], v[98:99]
    v_pk_mul_f32 v[92:93], v[92:93], v[78:79]
    v_pk_mul_f32 v[94:95], v[94:95], v[82:83]
    v_pk_mul_f32 v[96:97], v[96:97], v[86:87]
    v_pk_mul_f32 v[98:99], v[98:99], v[90:91]
    v_cvt_pk_bf16_f32 v244, v92, v93
    v_cvt_pk_bf16_f32 v245, v94, v95
    v_cvt_pk_bf16_f32 v246, v96, v97
    v_cvt_pk_bf16_f32 v247, v98, v99
    s_barrier
    ds_read_b128 v[80:83], v12 offset:0
    ds_read_b128 v[84:87], v13 offset:0
    ds_read_b128 v[88:91], v14 offset:0
    ds_read_b128 v[92:95], v15 offset:0
    ds_read_b64_tr_b16 v[112:113], v20 offset:16384
    ds_read_b64_tr_b16 v[114:115], v20 offset:17152
    ds_read_b64_tr_b16 v[116:117], v20 offset:16448
    ds_read_b64_tr_b16 v[118:119], v20 offset:17216
    ds_read_b64_tr_b16 v[120:121], v20 offset:16512
    ds_read_b64_tr_b16 v[122:123], v20 offset:17280
    ds_read_b64_tr_b16 v[124:125], v21 offset:16384
    ds_read_b64_tr_b16 v[126:127], v21 offset:17152
    ds_read_b64_tr_b16 v[128:129], v21 offset:16448
    ds_read_b64_tr_b16 v[130:131], v21 offset:17216
    ds_read_b64_tr_b16 v[132:133], v21 offset:16512
    ds_read_b64_tr_b16 v[134:135], v21 offset:17280
    s_waitcnt lgkmcnt(12)
    v_dot2c_f32_bf16 v160, s67, v80
    v_dot2c_f32_bf16 v162, v80, v80
    v_dot2c_f32_bf16 v161, s67, v81
    v_dot2c_f32_bf16 v163, v81, v81
    v_dot2c_f32_bf16 v160, s67, v82
    v_dot2c_f32_bf16 v162, v82, v82
    v_dot2c_f32_bf16 v161, s67, v83
    v_dot2c_f32_bf16 v163, v83, v83
    v_dot2c_f32_bf16 v160, s67, v84
    v_dot2c_f32_bf16 v162, v84, v84
    v_dot2c_f32_bf16 v161, s67, v85
    v_dot2c_f32_bf16 v163, v85, v85
    v_dot2c_f32_bf16 v160, s67, v86
    v_dot2c_f32_bf16 v162, v86, v86
    v_dot2c_f32_bf16 v161, s67, v87
    v_dot2c_f32_bf16 v163, v87, v87
    s_waitcnt lgkmcnt(6)
    v_dot2c_f32_bf16 v160, s67, v88
    v_dot2c_f32_bf16 v162, v88, v88
    v_dot2c_f32_bf16 v161, s67, v89
    v_dot2c_f32_bf16 v163, v89, v89
    v_dot2c_f32_bf16 v160, s67, v90
    v_dot2c_f32_bf16 v162, v90, v90
    v_dot2c_f32_bf16 v161, s67, v91
    v_dot2c_f32_bf16 v163, v91, v91
    v_dot2c_f32_bf16 v160, s67, v92
    v_dot2c_f32_bf16 v162, v92, v92
    v_dot2c_f32_bf16 v161, s67, v93
    v_dot2c_f32_bf16 v163, v93, v93
    v_dot2c_f32_bf16 v160, s67, v94
    v_dot2c_f32_bf16 v162, v94, v94
    v_dot2c_f32_bf16 v161, s67, v95
    v_dot2c_f32_bf16 v163, v95, v95
    v_dot2c_f32_bf16 v164, s67, v112
    v_dot2c_f32_bf16 v165, s67, v116
    v_dot2c_f32_bf16 v166, s67, v120
    v_dot2c_f32_bf16 v164, s67, v113
    v_dot2c_f32_bf16 v165, s67, v117
    v_dot2c_f32_bf16 v166, s67, v121
    v_dot2c_f32_bf16 v164, s67, v114
    v_dot2c_f32_bf16 v165, s67, v118
    v_dot2c_f32_bf16 v166, s67, v122
    v_dot2c_f32_bf16 v164, s67, v115
    v_dot2c_f32_bf16 v165, s67, v119
    v_dot2c_f32_bf16 v166, s67, v123
    v_mfma_f32_32x32x16_bf16 v[32:47], v[112:115], v[80:83], 0
    ds_read_b64_tr_b16 v[136:137], v22 offset:16384
    ds_read_b64_tr_b16 v[138:139], v22 offset:17152
    ds_read_b64_tr_b16 v[140:141], v22 offset:16448
    v_mfma_f32_32x32x16_bf16 v[48:63], v[116:119], v[80:83], 0
    ds_read_b64_tr_b16 v[142:143], v22 offset:17216
    ds_read_b64_tr_b16 v[144:145], v22 offset:16512
    ds_read_b64_tr_b16 v[146:147], v22 offset:17280
    v_mfma_f32_32x32x16_bf16 v[64:79], v[120:123], v[80:83], 0
    ds_read_b64_tr_b16 v[148:149], v23 offset:16384
    ds_read_b64_tr_b16 v[150:151], v23 offset:17152
    ds_read_b64_tr_b16 v[152:153], v23 offset:16448
    s_waitcnt lgkmcnt(13)
    v_mfma_f32_32x32x16_bf16 v[32:47], v[124:127], v[84:87], v[32:47]
    ds_read_b64_tr_b16 v[154:155], v23 offset:17216
    ds_read_b64_tr_b16 v[156:157], v23 offset:16512
    ds_read_b64_tr_b16 v[158:159], v23 offset:17280
    s_waitcnt lgkmcnt(14)
    v_mfma_f32_32x32x16_bf16 v[48:63], v[128:131], v[84:87], v[48:63]
    s_waitcnt lgkmcnt(12)
    v_mfma_f32_32x32x16_bf16 v[64:79], v[132:135], v[84:87], v[64:79]
    s_waitcnt lgkmcnt(10)
    v_mfma_f32_32x32x16_bf16 v[32:47], v[136:139], v[88:91], v[32:47]
    s_waitcnt lgkmcnt(8)
    v_mfma_f32_32x32x16_bf16 v[48:63], v[140:143], v[88:91], v[48:63]
    s_waitcnt lgkmcnt(6)
    v_mfma_f32_32x32x16_bf16 v[64:79], v[144:147], v[88:91], v[64:79]
    buffer_store_dwordx4 v[240:243], v215, s[36:39], s83 offen sc1
    buffer_store_dwordx4 v[244:247], v215, s[36:39], s86 offen sc1
    s_waitcnt lgkmcnt(0)
    s_barrier
    v_mfma_f32_32x32x16_bf16 v[32:47], v[148:151], v[92:95], v[32:47]
    ds_read_b128 v[96:99], v12 offset:28672
    ds_read_b128 v[100:103], v13 offset:28672
    ds_read_b128 v[104:107], v14 offset:28672
    ds_read_b128 v[108:111], v15 offset:28672
    ds_read_b64_tr_b16 v[112:113], v20 offset:45056
    ds_read_b64_tr_b16 v[114:115], v20 offset:45824
    v_mfma_f32_32x32x16_bf16 v[48:63], v[152:155], v[92:95], v[48:63]
    ds_read_b64_tr_b16 v[116:117], v20 offset:45120
    ds_read_b64_tr_b16 v[118:119], v20 offset:45888
    ds_read_b64_tr_b16 v[120:121], v20 offset:45184
    ds_read_b64_tr_b16 v[122:123], v20 offset:45952
    ds_read_b64_tr_b16 v[124:125], v21 offset:45056
    ds_read_b64_tr_b16 v[126:127], v21 offset:45824
    v_mfma_f32_32x32x16_bf16 v[64:79], v[156:159], v[92:95], v[64:79]
    ds_read_b64_tr_b16 v[128:129], v21 offset:45120
    ds_read_b64_tr_b16 v[130:131], v21 offset:45888
    ds_read_b64_tr_b16 v[132:133], v21 offset:45184
    ds_read_b64_tr_b16 v[134:135], v21 offset:45952
    s_waitcnt lgkmcnt(12)
    v_dot2c_f32_bf16 v160, s67, v96
    v_dot2c_f32_bf16 v162, v96, v96
    v_dot2c_f32_bf16 v161, s67, v97
    v_dot2c_f32_bf16 v163, v97, v97
    v_dot2c_f32_bf16 v160, s67, v98
    v_dot2c_f32_bf16 v162, v98, v98
    v_dot2c_f32_bf16 v161, s67, v99
    v_dot2c_f32_bf16 v163, v99, v99
    v_dot2c_f32_bf16 v160, s67, v100
    v_dot2c_f32_bf16 v162, v100, v100
    v_dot2c_f32_bf16 v161, s67, v101
    v_dot2c_f32_bf16 v163, v101, v101
    v_dot2c_f32_bf16 v160, s67, v102
    v_dot2c_f32_bf16 v162, v102, v102
    v_dot2c_f32_bf16 v161, s67, v103
    v_dot2c_f32_bf16 v163, v103, v103
    s_waitcnt lgkmcnt(6)
    v_dot2c_f32_bf16 v160, s67, v104
    v_dot2c_f32_bf16 v162, v104, v104
    v_dot2c_f32_bf16 v161, s67, v105
    v_dot2c_f32_bf16 v163, v105, v105
    v_dot2c_f32_bf16 v160, s67, v106
    v_dot2c_f32_bf16 v162, v106, v106
    v_dot2c_f32_bf16 v161, s67, v107
    v_dot2c_f32_bf16 v163, v107, v107
    v_dot2c_f32_bf16 v160, s67, v108
    v_dot2c_f32_bf16 v162, v108, v108
    v_dot2c_f32_bf16 v161, s67, v109
    v_dot2c_f32_bf16 v163, v109, v109
    v_dot2c_f32_bf16 v160, s67, v110
    v_dot2c_f32_bf16 v162, v110, v110
    v_dot2c_f32_bf16 v161, s67, v111
    v_dot2c_f32_bf16 v163, v111, v111
    v_dot2c_f32_bf16 v164, s67, v112
    v_dot2c_f32_bf16 v165, s67, v116
    v_dot2c_f32_bf16 v166, s67, v120
    v_dot2c_f32_bf16 v164, s67, v113
    v_dot2c_f32_bf16 v165, s67, v117
    v_dot2c_f32_bf16 v166, s67, v121
    v_dot2c_f32_bf16 v164, s67, v114
    v_dot2c_f32_bf16 v165, s67, v118
    v_dot2c_f32_bf16 v166, s67, v122
    v_dot2c_f32_bf16 v164, s67, v115
    v_dot2c_f32_bf16 v165, s67, v119
    v_dot2c_f32_bf16 v166, s67, v123
    v_mfma_f32_32x32x16_bf16 v[32:47], v[112:115], v[96:99], v[32:47]
    ds_read_b64_tr_b16 v[136:137], v22 offset:45056
    ds_read_b64_tr_b16 v[138:139], v22 offset:45824
    ds_read_b64_tr_b16 v[140:141], v22 offset:45120
    v_mfma_f32_32x32x16_bf16 v[48:63], v[116:119], v[96:99], v[48:63]
    ds_read_b64_tr_b16 v[142:143], v22 offset:45888
    ds_read_b64_tr_b16 v[144:145], v22 offset:45184
    ds_read_b64_tr_b16 v[146:147], v22 offset:45952
    v_mfma_f32_32x32x16_bf16 v[64:79], v[120:123], v[96:99], v[64:79]
    ds_read_b64_tr_b16 v[148:149], v23 offset:45056
    ds_read_b64_tr_b16 v[150:151], v23 offset:45824
    ds_read_b64_tr_b16 v[152:153], v23 offset:45120
    s_waitcnt lgkmcnt(13)
    v_mfma_f32_32x32x16_bf16 v[32:47], v[124:127], v[100:103], v[32:47]
    ds_read_b64_tr_b16 v[154:155], v23 offset:45888
    ds_read_b64_tr_b16 v[156:157], v23 offset:45184
    ds_read_b64_tr_b16 v[158:159], v23 offset:45952
    s_waitcnt lgkmcnt(14)
    v_mfma_f32_32x32x16_bf16 v[48:63], v[128:131], v[100:103], v[48:63]
    s_waitcnt lgkmcnt(12)
    v_mfma_f32_32x32x16_bf16 v[64:79], v[132:135], v[100:103], v[64:79]
    s_waitcnt lgkmcnt(10)
    v_mfma_f32_32x32x16_bf16 v[32:47], v[136:139], v[104:107], v[32:47]
    s_waitcnt lgkmcnt(8)
    v_mfma_f32_32x32x16_bf16 v[48:63], v[140:143], v[104:107], v[48:63]
    s_waitcnt lgkmcnt(6)
    v_mfma_f32_32x32x16_bf16 v[64:79], v[144:147], v[104:107], v[64:79]
    s_waitcnt lgkmcnt(0)
    s_barrier
    v_mfma_f32_32x32x16_bf16 v[32:47], v[148:151], v[108:111], v[32:47]
    ds_read_b128 v[80:83], v16 offset:0
    ds_read_b128 v[84:87], v17 offset:0
    ds_read_b128 v[88:91], v18 offset:0
    ds_read_b128 v[92:95], v19 offset:0
    ds_read_b64_tr_b16 v[112:113], v24 offset:16384
    ds_read_b64_tr_b16 v[114:115], v24 offset:17152
    v_mfma_f32_32x32x16_bf16 v[48:63], v[152:155], v[108:111], v[48:63]
    ds_read_b64_tr_b16 v[116:117], v24 offset:16448
    ds_read_b64_tr_b16 v[118:119], v24 offset:17216
    ds_read_b64_tr_b16 v[120:121], v24 offset:16512
    ds_read_b64_tr_b16 v[122:123], v24 offset:17280
    ds_read_b64_tr_b16 v[124:125], v25 offset:16384
    ds_read_b64_tr_b16 v[126:127], v25 offset:17152
    v_mfma_f32_32x32x16_bf16 v[64:79], v[156:159], v[108:111], v[64:79]
    ds_read_b64_tr_b16 v[128:129], v25 offset:16448
    ds_read_b64_tr_b16 v[130:131], v25 offset:17216
    ds_read_b64_tr_b16 v[132:133], v25 offset:16512
    ds_read_b64_tr_b16 v[134:135], v25 offset:17280
    s_waitcnt lgkmcnt(12)
    v_dot2c_f32_bf16 v160, s67, v80
    v_dot2c_f32_bf16 v162, v80, v80
    v_dot2c_f32_bf16 v161, s67, v81
    v_dot2c_f32_bf16 v163, v81, v81
    v_dot2c_f32_bf16 v160, s67, v82
    v_dot2c_f32_bf16 v162, v82, v82
    v_dot2c_f32_bf16 v161, s67, v83
    v_dot2c_f32_bf16 v163, v83, v83
    v_dot2c_f32_bf16 v160, s67, v84
    v_dot2c_f32_bf16 v162, v84, v84
    v_dot2c_f32_bf16 v161, s67, v85
    v_dot2c_f32_bf16 v163, v85, v85
    v_dot2c_f32_bf16 v160, s67, v86
    v_dot2c_f32_bf16 v162, v86, v86
    v_dot2c_f32_bf16 v161, s67, v87
    v_dot2c_f32_bf16 v163, v87, v87
    s_waitcnt lgkmcnt(6)
    v_dot2c_f32_bf16 v160, s67, v88
    v_dot2c_f32_bf16 v162, v88, v88
    v_dot2c_f32_bf16 v161, s67, v89
    v_dot2c_f32_bf16 v163, v89, v89
    v_dot2c_f32_bf16 v160, s67, v90
    v_dot2c_f32_bf16 v162, v90, v90
    v_dot2c_f32_bf16 v161, s67, v91
    v_dot2c_f32_bf16 v163, v91, v91
    v_dot2c_f32_bf16 v160, s67, v92
    v_dot2c_f32_bf16 v162, v92, v92
    v_dot2c_f32_bf16 v161, s67, v93
    v_dot2c_f32_bf16 v163, v93, v93
    v_dot2c_f32_bf16 v160, s67, v94
    v_dot2c_f32_bf16 v162, v94, v94
    v_dot2c_f32_bf16 v161, s67, v95
    v_dot2c_f32_bf16 v163, v95, v95
    v_dot2c_f32_bf16 v164, s67, v112
    v_dot2c_f32_bf16 v165, s67, v116
    v_dot2c_f32_bf16 v166, s67, v120
    v_dot2c_f32_bf16 v164, s67, v113
    v_dot2c_f32_bf16 v165, s67, v117
    v_dot2c_f32_bf16 v166, s67, v121
    v_dot2c_f32_bf16 v164, s67, v114
    v_dot2c_f32_bf16 v165, s67, v118
    v_dot2c_f32_bf16 v166, s67, v122
    v_dot2c_f32_bf16 v164, s67, v115
    v_dot2c_f32_bf16 v165, s67, v119
    v_dot2c_f32_bf16 v166, s67, v123
    v_mfma_f32_32x32x16_bf16 v[32:47], v[112:115], v[80:83], v[32:47]
    ds_read_b64_tr_b16 v[136:137], v26 offset:16384
    ds_read_b64_tr_b16 v[138:139], v26 offset:17152
    ds_read_b64_tr_b16 v[140:141], v26 offset:16448
    v_mfma_f32_32x32x16_bf16 v[48:63], v[116:119], v[80:83], v[48:63]
    ds_read_b64_tr_b16 v[142:143], v26 offset:17216
    ds_read_b64_tr_b16 v[144:145], v26 offset:16512
    ds_read_b64_tr_b16 v[146:147], v26 offset:17280
    v_mfma_f32_32x32x16_bf16 v[64:79], v[120:123], v[80:83], v[64:79]
    ds_read_b64_tr_b16 v[148:149], v27 offset:16384
    ds_read_b64_tr_b16 v[150:151], v27 offset:17152
    ds_read_b64_tr_b16 v[152:153], v27 offset:16448
    s_waitcnt lgkmcnt(13)
    v_mfma_f32_32x32x16_bf16 v[32:47], v[124:127], v[84:87], v[32:47]
    ds_read_b64_tr_b16 v[154:155], v27 offset:17216
    ds_read_b64_tr_b16 v[156:157], v27 offset:16512
    ds_read_b64_tr_b16 v[158:159], v27 offset:17280
    s_waitcnt lgkmcnt(14)
    v_mfma_f32_32x32x16_bf16 v[48:63], v[128:131], v[84:87], v[48:63]
    s_waitcnt lgkmcnt(12)
    v_mfma_f32_32x32x16_bf16 v[64:79], v[132:135], v[84:87], v[64:79]
    s_waitcnt lgkmcnt(10)
    v_mfma_f32_32x32x16_bf16 v[32:47], v[136:139], v[88:91], v[32:47]
    s_waitcnt lgkmcnt(8)
    v_mfma_f32_32x32x16_bf16 v[48:63], v[140:143], v[88:91], v[48:63]
    s_waitcnt lgkmcnt(6)
    v_mfma_f32_32x32x16_bf16 v[64:79], v[144:147], v[88:91], v[64:79]
    s_waitcnt vmcnt(0)
    s_mov_b32 s82, 0
    s_mov_b64 exec, 0xffff
    buffer_store_dwordx2 v[252:253], v28, s[36:39], s82 offen sc1
    s_mov_b64 exec, -1
    s_waitcnt lgkmcnt(0)
    s_barrier
    v_mfma_f32_32x32x16_bf16 v[32:47], v[148:151], v[92:95], v[32:47]
    ds_read_b128 v[96:99], v16 offset:28672
    ds_read_b128 v[100:103], v17 offset:28672
    ds_read_b128 v[104:107], v18 offset:28672
    ds_read_b128 v[108:111], v19 offset:28672
    ds_read_b64_tr_b16 v[112:113], v24 offset:45056
    ds_read_b64_tr_b16 v[114:115], v24 offset:45824
    v_mfma_f32_32x32x16_bf16 v[48:63], v[152:155], v[92:95], v[48:63]
    ds_read_b64_tr_b16 v[116:117], v24 offset:45120
    ds_read_b64_tr_b16 v[118:119], v24 offset:45888
    ds_read_b64_tr_b16 v[120:121], v24 offset:45184
    ds_read_b64_tr_b16 v[122:123], v24 offset:45952
    ds_read_b64_tr_b16 v[124:125], v25 offset:45056
    ds_read_b64_tr_b16 v[126:127], v25 offset:45824
    v_mfma_f32_32x32x16_bf16 v[64:79], v[156:159], v[92:95], v[64:79]
    ds_read_b64_tr_b16 v[128:129], v25 offset:45120
    ds_read_b64_tr_b16 v[130:131], v25 offset:45888
    ds_read_b64_tr_b16 v[132:133], v25 offset:45184
    ds_read_b64_tr_b16 v[134:135], v25 offset:45952
    s_waitcnt lgkmcnt(12)
    v_dot2c_f32_bf16 v160, s67, v96
    v_dot2c_f32_bf16 v162, v96, v96
    v_dot2c_f32_bf16 v161, s67, v97
    v_dot2c_f32_bf16 v163, v97, v97
    v_dot2c_f32_bf16 v160, s67, v98
    v_dot2c_f32_bf16 v162, v98, v98
    v_dot2c_f32_bf16 v161, s67, v99
    v_dot2c_f32_bf16 v163, v99, v99
    v_dot2c_f32_bf16 v160, s67, v100
    v_dot2c_f32_bf16 v162, v100, v100
    v_dot2c_f32_bf16 v161, s67, v101
    v_dot2c_f32_bf16 v163, v101, v101
    v_dot2c_f32_bf16 v160, s67, v102
    v_dot2c_f32_bf16 v162, v102, v102
    v_dot2c_f32_bf16 v161, s67, v103
    v_dot2c_f32_bf16 v163, v103, v103
    s_waitcnt lgkmcnt(6)
    v_dot2c_f32_bf16 v160, s67, v104
    v_dot2c_f32_bf16 v162, v104, v104
    v_dot2c_f32_bf16 v161, s67, v105
    v_dot2c_f32_bf16 v163, v105, v105
    v_dot2c_f32_bf16 v160, s67, v106
    v_dot2c_f32_bf16 v162, v106, v106
    v_dot2c_f32_bf16 v161, s67, v107
    v_dot2c_f32_bf16 v163, v107, v107
    v_dot2c_f32_bf16 v160, s67, v108
    v_dot2c_f32_bf16 v162, v108, v108
    v_dot2c_f32_bf16 v161, s67, v109
    v_dot2c_f32_bf16 v163, v109, v109
    v_dot2c_f32_bf16 v160, s67, v110
    v_dot2c_f32_bf16 v162, v110, v110
    v_dot2c_f32_bf16 v161, s67, v111
    v_dot2c_f32_bf16 v163, v111, v111
    v_dot2c_f32_bf16 v164, s67, v112
    v_dot2c_f32_bf16 v165, s67, v116
    v_dot2c_f32_bf16 v166, s67, v120
    v_dot2c_f32_bf16 v164, s67, v113
    v_dot2c_f32_bf16 v165, s67, v117
    v_dot2c_f32_bf16 v166, s67, v121
    v_dot2c_f32_bf16 v164, s67, v114
    v_dot2c_f32_bf16 v165, s67, v118
    v_dot2c_f32_bf16 v166, s67, v122
    v_dot2c_f32_bf16 v164, s67, v115
    v_dot2c_f32_bf16 v165, s67, v119
    v_dot2c_f32_bf16 v166, s67, v123
    v_mfma_f32_32x32x16_bf16 v[32:47], v[112:115], v[96:99], v[32:47]
    ds_read_b64_tr_b16 v[136:137], v26 offset:45056
    ds_read_b64_tr_b16 v[138:139], v26 offset:45824
    ds_read_b64_tr_b16 v[140:141], v26 offset:45120
    v_mfma_f32_32x32x16_bf16 v[48:63], v[116:119], v[96:99], v[48:63]
    ds_read_b64_tr_b16 v[142:143], v26 offset:45888
    ds_read_b64_tr_b16 v[144:145], v26 offset:45184
    ds_read_b64_tr_b16 v[146:147], v26 offset:45952
    v_mfma_f32_32x32x16_bf16 v[64:79], v[120:123], v[96:99], v[64:79]
    ds_read_b64_tr_b16 v[148:149], v27 offset:45056
    ds_read_b64_tr_b16 v[150:151], v27 offset:45824
    ds_read_b64_tr_b16 v[152:153], v27 offset:45120
    s_waitcnt lgkmcnt(13)
    v_mfma_f32_32x32x16_bf16 v[32:47], v[124:127], v[100:103], v[32:47]
    ds_read_b64_tr_b16 v[154:155], v27 offset:45888
    ds_read_b64_tr_b16 v[156:157], v27 offset:45184
    ds_read_b64_tr_b16 v[158:159], v27 offset:45952
    s_waitcnt lgkmcnt(14)
    v_mfma_f32_32x32x16_bf16 v[48:63], v[128:131], v[100:103], v[48:63]
    s_waitcnt lgkmcnt(12)
    v_mfma_f32_32x32x16_bf16 v[64:79], v[132:135], v[100:103], v[64:79]
    s_waitcnt lgkmcnt(10)
    v_mfma_f32_32x32x16_bf16 v[32:47], v[136:139], v[104:107], v[32:47]
    s_waitcnt lgkmcnt(8)
    v_mfma_f32_32x32x16_bf16 v[48:63], v[140:143], v[104:107], v[48:63]
    s_waitcnt lgkmcnt(6)
    v_mfma_f32_32x32x16_bf16 v[64:79], v[144:147], v[104:107], v[64:79]
    s_waitcnt lgkmcnt(0)
    s_barrier
    v_mfma_f32_32x32x16_bf16 v[32:47], v[148:151], v[108:111], v[32:47]
    ds_read_b128 v[80:83], v12 offset:0
    ds_read_b128 v[84:87], v13 offset:0
    ds_read_b128 v[88:91], v14 offset:0
    ds_read_b128 v[92:95], v15 offset:0
    ds_read_b64_tr_b16 v[112:113], v20 offset:16384
    ds_read_b64_tr_b16 v[114:115], v20 offset:17152
    v_mfma_f32_32x32x16_bf16 v[48:63], v[152:155], v[108:111], v[48:63]
    ds_read_b64_tr_b16 v[116:117], v20 offset:16448
    ds_read_b64_tr_b16 v[118:119], v20 offset:17216
    ds_read_b64_tr_b16 v[120:121], v20 offset:16512
    ds_read_b64_tr_b16 v[122:123], v20 offset:17280
    ds_read_b64_tr_b16 v[124:125], v21 offset:16384
    ds_read_b64_tr_b16 v[126:127], v21 offset:17152
    v_mfma_f32_32x32x16_bf16 v[64:79], v[156:159], v[108:111], v[64:79]
    ds_read_b64_tr_b16 v[128:129], v21 offset:16448
    ds_read_b64_tr_b16 v[130:131], v21 offset:17216
    ds_read_b64_tr_b16 v[132:133], v21 offset:16512
    ds_read_b64_tr_b16 v[134:135], v21 offset:17280
    s_waitcnt lgkmcnt(12)
    v_dot2c_f32_bf16 v160, s67, v80
    v_dot2c_f32_bf16 v162, v80, v80
    v_dot2c_f32_bf16 v161, s67, v81
    v_dot2c_f32_bf16 v163, v81, v81
    v_dot2c_f32_bf16 v160, s67, v82
    v_dot2c_f32_bf16 v162, v82, v82
    v_dot2c_f32_bf16 v161, s67, v83
    v_dot2c_f32_bf16 v163, v83, v83
    v_dot2c_f32_bf16 v160, s67, v84
    v_dot2c_f32_bf16 v162, v84, v84
    v_dot2c_f32_bf16 v161, s67, v85
    v_dot2c_f32_bf16 v163, v85, v85
    v_dot2c_f32_bf16 v160, s67, v86
    v_dot2c_f32_bf16 v162, v86, v86
    v_dot2c_f32_bf16 v161, s67, v87
    v_dot2c_f32_bf16 v163, v87, v87
    s_waitcnt lgkmcnt(6)
    v_dot2c_f32_bf16 v160, s67, v88
    v_dot2c_f32_bf16 v162, v88, v88
    v_dot2c_f32_bf16 v161, s67, v89
    v_dot2c_f32_bf16 v163, v89, v89
    v_dot2c_f32_bf16 v160, s67, v90
    v_dot2c_f32_bf16 v162, v90, v90
    v_dot2c_f32_bf16 v161, s67, v91
    v_dot2c_f32_bf16 v163, v91, v91
    v_dot2c_f32_bf16 v160, s67, v92
    v_dot2c_f32_bf16 v162, v92, v92
    v_dot2c_f32_bf16 v161, s67, v93
    v_dot2c_f32_bf16 v163, v93, v93
    v_dot2c_f32_bf16 v160, s67, v94
    v_dot2c_f32_bf16 v162, v94, v94
    v_dot2c_f32_bf16 v161, s67, v95
    v_dot2c_f32_bf16 v163, v95, v95
    v_dot2c_f32_bf16 v164, s67, v112
    v_dot2c_f32_bf16 v165, s67, v116
    v_dot2c_f32_bf16 v166, s67, v120
    v_dot2c_f32_bf16 v164, s67, v113
    v_dot2c_f32_bf16 v165, s67, v117
    v_dot2c_f32_bf16 v166, s67, v121
    v_dot2c_f32_bf16 v164, s67, v114
    v_dot2c_f32_bf16 v165, s67, v118
    v_dot2c_f32_bf16 v166, s67, v122
    v_dot2c_f32_bf16 v164, s67, v115
    v_dot2c_f32_bf16 v165, s67, v119
    v_dot2c_f32_bf16 v166, s67, v123
    v_mfma_f32_32x32x16_bf16 v[32:47], v[112:115], v[80:83], v[32:47]
    ds_read_b64_tr_b16 v[136:137], v22 offset:16384
    ds_read_b64_tr_b16 v[138:139], v22 offset:17152
    ds_read_b64_tr_b16 v[140:141], v22 offset:16448
    v_mfma_f32_32x32x16_bf16 v[48:63], v[116:119], v[80:83], v[48:63]
    ds_read_b64_tr_b16 v[142:143], v22 offset:17216
    ds_read_b64_tr_b16 v[144:145], v22 offset:16512
    ds_read_b64_tr_b16 v[146:147], v22 offset:17280
    v_mfma_f32_32x32x16_bf16 v[64:79], v[120:123], v[80:83], v[64:79]
    ds_read_b64_tr_b16 v[148:149], v23 offset:16384
    ds_read_b64_tr_b16 v[150:151], v23 offset:17152
    ds_read_b64_tr_b16 v[152:153], v23 offset:16448
    s_waitcnt lgkmcnt(13)
    v_mfma_f32_32x32x16_bf16 v[32:47], v[124:127], v[84:87], v[32:47]
    ds_read_b64_tr_b16 v[154:155], v23 offset:17216
    ds_read_b64_tr_b16 v[156:157], v23 offset:16512
    ds_read_b64_tr_b16 v[158:159], v23 offset:17280
    s_waitcnt lgkmcnt(14)
    v_mfma_f32_32x32x16_bf16 v[48:63], v[128:131], v[84:87], v[48:63]
    s_waitcnt lgkmcnt(12)
    v_mfma_f32_32x32x16_bf16 v[64:79], v[132:135], v[84:87], v[64:79]
    s_waitcnt lgkmcnt(10)
    v_mfma_f32_32x32x16_bf16 v[32:47], v[136:139], v[88:91], v[32:47]
    ds_read_b128 v[4:7], v29 offset:0
    s_waitcnt lgkmcnt(9)
    v_mfma_f32_32x32x16_bf16 v[48:63], v[140:143], v[88:91], v[48:63]
    s_waitcnt lgkmcnt(7)
    v_mfma_f32_32x32x16_bf16 v[64:79], v[144:147], v[88:91], v[64:79]
    s_waitcnt lgkmcnt(0)
C4:
    v_min3_u32 v4, v4, v5, v6
    v_min_u32 v4, v4, v7
    v_cmp_gt_u32 vcc, 1, v4
    s_cbranch_vccz C5
    ds_read_b128 v[4:7], v29 offset:0
    s_waitcnt lgkmcnt(0)
    s_branch C4
C5:
    v_mfma_f32_32x32x16_bf16 v[32:47], v[148:151], v[92:95], v[32:47]
    ds_read_b128 v[96:99], v12 offset:28672
    ds_read_b128 v[100:103], v13 offset:28672
    ds_read_b128 v[104:107], v14 offset:28672
    ds_read_b128 v[108:111], v15 offset:28672
    ds_read_b64_tr_b16 v[112:113], v20 offset:45056
    ds_read_b64_tr_b16 v[114:115], v20 offset:45824
    v_mfma_f32_32x32x16_bf16 v[48:63], v[152:155], v[92:95], v[48:63]
    ds_read_b64_tr_b16 v[116:117], v20 offset:45120
    ds_read_b64_tr_b16 v[118:119], v20 offset:45888
    ds_read_b64_tr_b16 v[120:121], v20 offset:45184
    ds_read_b64_tr_b16 v[122:123], v20 offset:45952
    ds_read_b64_tr_b16 v[124:125], v21 offset:45056
    ds_read_b64_tr_b16 v[126:127], v21 offset:45824
    v_mfma_f32_32x32x16_bf16 v[64:79], v[156:159], v[92:95], v[64:79]
    ds_read_b64_tr_b16 v[128:129], v21 offset:45120
    ds_read_b64_tr_b16 v[130:131], v21 offset:45888
    ds_read_b64_tr_b16 v[132:133], v21 offset:45184
    ds_read_b64_tr_b16 v[134:135], v21 offset:45952
    s_waitcnt lgkmcnt(12)
    v_dot2c_f32_bf16 v160, s67, v96
    v_dot2c_f32_bf16 v162, v96, v96
    v_dot2c_f32_bf16 v161, s67, v97
    v_dot2c_f32_bf16 v163, v97, v97
    v_dot2c_f32_bf16 v160, s67, v98
    v_dot2c_f32_bf16 v162, v98, v98
    v_dot2c_f32_bf16 v161, s67, v99
    v_dot2c_f32_bf16 v163, v99, v99
    v_dot2c_f32_bf16 v160, s67, v100
    v_dot2c_f32_bf16 v162, v100, v100
    v_dot2c_f32_bf16 v161, s67, v101
    v_dot2c_f32_bf16 v163, v101, v101
    v_dot2c_f32_bf16 v160, s67, v102
    v_dot2c_f32_bf16 v162, v102, v102
    v_dot2c_f32_bf16 v161, s67, v103
    v_dot2c_f32_bf16 v163, v103, v103
    s_waitcnt lgkmcnt(6)
    v_dot2c_f32_bf16 v160, s67, v104
    v_dot2c_f32_bf16 v162, v104, v104
    v_dot2c_f32_bf16 v161, s67, v105
    v_dot2c_f32_bf16 v163, v105, v105
    v_dot2c_f32_bf16 v160, s67, v106
    v_dot2c_f32_bf16 v162, v106, v106
    v_dot2c_f32_bf16 v161, s67, v107
    v_dot2c_f32_bf16 v163, v107, v107
    v_dot2c_f32_bf16 v160, s67, v108
    v_dot2c_f32_bf16 v162, v108, v108
    v_dot2c_f32_bf16 v161, s67, v109
    v_dot2c_f32_bf16 v163, v109, v109
    v_dot2c_f32_bf16 v160, s67, v110
    v_dot2c_f32_bf16 v162, v110, v110
    v_dot2c_f32_bf16 v161, s67, v111
    v_dot2c_f32_bf16 v163, v111, v111
    v_dot2c_f32_bf16 v164, s67, v112
    v_dot2c_f32_bf16 v165, s67, v116
    v_dot2c_f32_bf16 v166, s67, v120
    v_dot2c_f32_bf16 v164, s67, v113
    v_dot2c_f32_bf16 v165, s67, v117
    v_dot2c_f32_bf16 v166, s67, v121
    v_dot2c_f32_bf16 v164, s67, v114
    v_dot2c_f32_bf16 v165, s67, v118
    v_dot2c_f32_bf16 v166, s67, v122
    v_dot2c_f32_bf16 v164, s67, v115
    v_dot2c_f32_bf16 v165, s67, v119
    v_dot2c_f32_bf16 v166, s67, v123
    v_mfma_f32_32x32x16_bf16 v[32:47], v[112:115], v[96:99], v[32:47]
    ds_read_b64_tr_b16 v[136:137], v22 offset:45056
    ds_read_b64_tr_b16 v[138:139], v22 offset:45824
    ds_read_b64_tr_b16 v[140:141], v22 offset:45120
    v_mfma_f32_32x32x16_bf16 v[48:63], v[116:119], v[96:99], v[48:63]
    ds_read_b64_tr_b16 v[142:143], v22 offset:45888
    ds_read_b64_tr_b16 v[144:145], v22 offset:45184
    ds_read_b64_tr_b16 v[146:147], v22 offset:45952
    v_mfma_f32_32x32x16_bf16 v[64:79], v[120:123], v[96:99], v[64:79]
    ds_read_b64_tr_b16 v[148:149], v23 offset:45056
    ds_read_b64_tr_b16 v[150:151], v23 offset:45824
    ds_read_b64_tr_b16 v[152:153], v23 offset:45120
    s_waitcnt lgkmcnt(13)
    v_mfma_f32_32x32x16_bf16 v[32:47], v[124:127], v[100:103], v[32:47]
    ds_read_b64_tr_b16 v[154:155], v23 offset:45888
    ds_read_b64_tr_b16 v[156:157], v23 offset:45184
    ds_read_b64_tr_b16 v[158:159], v23 offset:45952
    s_waitcnt lgkmcnt(14)
    v_mfma_f32_32x32x16_bf16 v[48:63], v[128:131], v[100:103], v[48:63]
    s_waitcnt lgkmcnt(12)
    v_mfma_f32_32x32x16_bf16 v[64:79], v[132:135], v[100:103], v[64:79]
    s_waitcnt lgkmcnt(10)
    v_mfma_f32_32x32x16_bf16 v[32:47], v[136:139], v[104:107], v[32:47]
    ds_read_b128 v[4:7], v29 offset:0
    s_waitcnt lgkmcnt(9)
    v_mfma_f32_32x32x16_bf16 v[48:63], v[140:143], v[104:107], v[48:63]
    s_waitcnt lgkmcnt(7)
    v_mfma_f32_32x32x16_bf16 v[64:79], v[144:147], v[104:107], v[64:79]
    s_waitcnt lgkmcnt(0)
C6:
    v_min3_u32 v4, v4, v5, v6
    v_min_u32 v4, v4, v7
    v_cmp_gt_u32 vcc, 2, v4
    s_cbranch_vccz C7
    ds_read_b128 v[4:7], v29 offset:0
    s_waitcnt lgkmcnt(0)
    s_branch C6
C7:
    v_mfma_f32_32x32x16_bf16 v[32:47], v[148:151], v[108:111], v[32:47]
    ds_read_b128 v[80:83], v16 offset:0
    ds_read_b128 v[84:87], v17 offset:0
    ds_read_b128 v[88:91], v18 offset:0
    ds_read_b128 v[92:95], v19 offset:0
    ds_read_b64_tr_b16 v[112:113], v24 offset:16384
    ds_read_b64_tr_b16 v[114:115], v24 offset:17152
    v_mfma_f32_32x32x16_bf16 v[48:63], v[152:155], v[108:111], v[48:63]
    ds_read_b64_tr_b16 v[116:117], v24 offset:16448
    ds_read_b64_tr_b16 v[118:119], v24 offset:17216
    ds_read_b64_tr_b16 v[120:121], v24 offset:16512
    ds_read_b64_tr_b16 v[122:123], v24 offset:17280
    ds_read_b64_tr_b16 v[124:125], v25 offset:16384
    ds_read_b64_tr_b16 v[126:127], v25 offset:17152
    v_mfma_f32_32x32x16_bf16 v[64:79], v[156:159], v[108:111], v[64:79]
    ds_read_b64_tr_b16 v[128:129], v25 offset:16448
    ds_read_b64_tr_b16 v[130:131], v25 offset:17216
    ds_read_b64_tr_b16 v[132:133], v25 offset:16512
    ds_read_b64_tr_b16 v[134:135], v25 offset:17280
    s_waitcnt lgkmcnt(12)
    v_dot2c_f32_bf16 v160, s67, v80
    v_dot2c_f32_bf16 v162, v80, v80
    v_dot2c_f32_bf16 v161, s67, v81
    v_dot2c_f32_bf16 v163, v81, v81
    v_dot2c_f32_bf16 v160, s67, v82
    v_dot2c_f32_bf16 v162, v82, v82
    v_dot2c_f32_bf16 v161, s67, v83
    v_dot2c_f32_bf16 v163, v83, v83
    v_dot2c_f32_bf16 v160, s67, v84
    v_dot2c_f32_bf16 v162, v84, v84
    v_dot2c_f32_bf16 v161, s67, v85
    v_dot2c_f32_bf16 v163, v85, v85
    v_dot2c_f32_bf16 v160, s67, v86
    v_dot2c_f32_bf16 v162, v86, v86
    v_dot2c_f32_bf16 v161, s67, v87
    v_dot2c_f32_bf16 v163, v87, v87
    s_waitcnt lgkmcnt(6)
    v_dot2c_f32_bf16 v160, s67, v88
    v_dot2c_f32_bf16 v162, v88, v88
    v_dot2c_f32_bf16 v161, s67, v89
    v_dot2c_f32_bf16 v163, v89, v89
    v_dot2c_f32_bf16 v160, s67, v90
    v_dot2c_f32_bf16 v162, v90, v90
    v_dot2c_f32_bf16 v161, s67, v91
    v_dot2c_f32_bf16 v163, v91, v91
    v_dot2c_f32_bf16 v160, s67, v92
    v_dot2c_f32_bf16 v162, v92, v92
    v_dot2c_f32_bf16 v161, s67, v93
    v_dot2c_f32_bf16 v163, v93, v93
    v_dot2c_f32_bf16 v160, s67, v94
    v_dot2c_f32_bf16 v162, v94, v94
    v_dot2c_f32_bf16 v161, s67, v95
    v_dot2c_f32_bf16 v163, v95, v95
    v_dot2c_f32_bf16 v164, s67, v112
    v_dot2c_f32_bf16 v165, s67, v116
    v_dot2c_f32_bf16 v166, s67, v120
    v_dot2c_f32_bf16 v164, s67, v113
    v_dot2c_f32_bf16 v165, s67, v117
    v_dot2c_f32_bf16 v166, s67, v121
    v_dot2c_f32_bf16 v164, s67, v114
    v_dot2c_f32_bf16 v165, s67, v118
    v_dot2c_f32_bf16 v166, s67, v122
    v_dot2c_f32_bf16 v164, s67, v115
    v_dot2c_f32_bf16 v165, s67, v119
    v_dot2c_f32_bf16 v166, s67, v123
    v_mfma_f32_32x32x16_bf16 v[32:47], v[112:115], v[80:83], v[32:47]
    ds_read_b64_tr_b16 v[136:137], v26 offset:16384
    ds_read_b64_tr_b16 v[138:139], v26 offset:17152
    ds_read_b64_tr_b16 v[140:141], v26 offset:16448
    v_mfma_f32_32x32x16_bf16 v[48:63], v[116:119], v[80:83], v[48:63]
    ds_read_b64_tr_b16 v[142:143], v26 offset:17216
    ds_read_b64_tr_b16 v[144:145], v26 offset:16512
    ds_read_b64_tr_b16 v[146:147], v26 offset:17280
    v_mfma_f32_32x32x16_bf16 v[64:79], v[120:123], v[80:83], v[64:79]
    ds_read_b64_tr_b16 v[148:149], v27 offset:16384
    ds_read_b64_tr_b16 v[150:151], v27 offset:17152
    ds_read_b64_tr_b16 v[152:153], v27 offset:16448
    s_waitcnt lgkmcnt(13)
    v_mfma_f32_32x32x16_bf16 v[32:47], v[124:127], v[84:87], v[32:47]
    ds_read_b64_tr_b16 v[154:155], v27 offset:17216
    ds_read_b64_tr_b16 v[156:157], v27 offset:16512
    ds_read_b64_tr_b16 v[158:159], v27 offset:17280
    s_waitcnt lgkmcnt(14)
    v_mfma_f32_32x32x16_bf16 v[48:63], v[128:131], v[84:87], v[48:63]
    s_waitcnt lgkmcnt(12)
    v_mfma_f32_32x32x16_bf16 v[64:79], v[132:135], v[84:87], v[64:79]
    s_waitcnt lgkmcnt(10)
    v_mfma_f32_32x32x16_bf16 v[32:47], v[136:139], v[88:91], v[32:47]
    ds_read_b128 v[4:7], v29 offset:0
    s_waitcnt lgkmcnt(9)
    v_mfma_f32_32x32x16_bf16 v[48:63], v[140:143], v[88:91], v[48:63]
    s_waitcnt lgkmcnt(7)
    v_mfma_f32_32x32x16_bf16 v[64:79], v[144:147], v[88:91], v[64:79]
    s_waitcnt lgkmcnt(0)
C8:
    v_min3_u32 v4, v4, v5, v6
    v_min_u32 v4, v4, v7
    v_cmp_gt_u32 vcc, 3, v4
    s_cbranch_vccz C9
    ds_read_b128 v[4:7], v29 offset:0
    s_waitcnt lgkmcnt(0)
    s_branch C8
C9:
    v_mfma_f32_32x32x16_bf16 v[32:47], v[148:151], v[92:95], v[32:47]
    ds_read_b128 v[96:99], v16 offset:28672
    ds_read_b128 v[100:103], v17 offset:28672
    ds_read_b128 v[104:107], v18 offset:28672
    ds_read_b128 v[108:111], v19 offset:28672
    ds_read_b64_tr_b16 v[112:113], v24 offset:45056
    ds_read_b64_tr_b16 v[114:115], v24 offset:45824
    v_mfma_f32_32x32x16_bf16 v[48:63], v[152:155], v[92:95], v[48:63]
    ds_read_b64_tr_b16 v[116:117], v24 offset:45120
    ds_read_b64_tr_b16 v[118:119], v24 offset:45888
    ds_read_b64_tr_b16 v[120:121], v24 offset:45184
    ds_read_b64_tr_b16 v[122:123], v24 offset:45952
    ds_read_b64_tr_b16 v[124:125], v25 offset:45056
    ds_read_b64_tr_b16 v[126:127], v25 offset:45824
    v_mfma_f32_32x32x16_bf16 v[64:79], v[156:159], v[92:95], v[64:79]
    ds_read_b64_tr_b16 v[128:129], v25 offset:45120
    ds_read_b64_tr_b16 v[130:131], v25 offset:45888
    ds_read_b64_tr_b16 v[132:133], v25 offset:45184
    ds_read_b64_tr_b16 v[134:135], v25 offset:45952
    s_waitcnt lgkmcnt(12)
    v_dot2c_f32_bf16 v160, s67, v96
    v_dot2c_f32_bf16 v162, v96, v96
    v_dot2c_f32_bf16 v161, s67, v97
    v_dot2c_f32_bf16 v163, v97, v97
    v_dot2c_f32_bf16 v160, s67, v98
    v_dot2c_f32_bf16 v162, v98, v98
    v_dot2c_f32_bf16 v161, s67, v99
    v_dot2c_f32_bf16 v163, v99, v99
    v_dot2c_f32_bf16 v160, s67, v100
    v_dot2c_f32_bf16 v162, v100, v100
    v_dot2c_f32_bf16 v161, s67, v101
    v_dot2c_f32_bf16 v163, v101, v101
    v_dot2c_f32_bf16 v160, s67, v102
    v_dot2c_f32_bf16 v162, v102, v102
    v_dot2c_f32_bf16 v161, s67, v103
    v_dot2c_f32_bf16 v163, v103, v103
    s_waitcnt lgkmcnt(6)
    v_dot2c_f32_bf16 v160, s67, v104
    v_dot2c_f32_bf16 v162, v104, v104
    v_dot2c_f32_bf16 v161, s67, v105
    v_dot2c_f32_bf16 v163, v105, v105
    v_dot2c_f32_bf16 v160, s67, v106
    v_dot2c_f32_bf16 v162, v106, v106
    v_dot2c_f32_bf16 v161, s67, v107
    v_dot2c_f32_bf16 v163, v107, v107
    v_dot2c_f32_bf16 v160, s67, v108
    v_dot2c_f32_bf16 v162, v108, v108
    v_dot2c_f32_bf16 v161, s67, v109
    v_dot2c_f32_bf16 v163, v109, v109
    v_dot2c_f32_bf16 v160, s67, v110
    v_dot2c_f32_bf16 v162, v110, v110
    v_dot2c_f32_bf16 v161, s67, v111
    v_dot2c_f32_bf16 v163, v111, v111
    v_dot2c_f32_bf16 v164, s67, v112
    v_dot2c_f32_bf16 v165, s67, v116
    v_dot2c_f32_bf16 v166, s67, v120
    v_dot2c_f32_bf16 v164, s67, v113
    v_dot2c_f32_bf16 v165, s67, v117
    v_dot2c_f32_bf16 v166, s67, v121
    v_dot2c_f32_bf16 v164, s67, v114
    v_dot2c_f32_bf16 v165, s67, v118
    v_dot2c_f32_bf16 v166, s67, v122
    v_dot2c_f32_bf16 v164, s67, v115
    v_dot2c_f32_bf16 v165, s67, v119
    v_dot2c_f32_bf16 v166, s67, v123
    v_mfma_f32_32x32x16_bf16 v[32:47], v[112:115], v[96:99], v[32:47]
    ds_read_b64_tr_b16 v[136:137], v26 offset:45056
    ds_read_b64_tr_b16 v[138:139], v26 offset:45824
    ds_read_b64_tr_b16 v[140:141], v26 offset:45120
    v_and_b32 v192, s73, v164
    v_mfma_f32_32x32x16_bf16 v[48:63], v[116:119], v[96:99], v[48:63]
    ds_read_b64_tr_b16 v[142:143], v26 offset:45888
    ds_read_b64_tr_b16 v[144:145], v26 offset:45184
    ds_read_b64_tr_b16 v[146:147], v26 offset:45952
    v_sub_f32 v195, v164, v192
    v_mfma_f32_32x32x16_bf16 v[64:79], v[120:123], v[96:99], v[64:79]
    ds_read_b64_tr_b16 v[148:149], v27 offset:45056
    ds_read_b64_tr_b16 v[150:151], v27 offset:45824
    ds_read_b64_tr_b16 v[152:153], v27 offset:45120
    v_and_b32 v193, s73, v165
    s_waitcnt lgkmcnt(13)
    v_mfma_f32_32x32x16_bf16 v[32:47], v[124:127], v[100:103], v[32:47]
    ds_read_b64_tr_b16 v[154:155], v27 offset:45888
    ds_read_b64_tr_b16 v[156:157], v27 offset:45184
    ds_read_b64_tr_b16 v[158:159], v27 offset:45952
    v_sub_f32 v196, v165, v193
    s_waitcnt lgkmcnt(14)
    v_mfma_f32_32x32x16_bf16 v[48:63], v[128:131], v[100:103], v[48:63]
    v_and_b32 v194, s73, v166
    v_sub_f32 v197, v166, v194
    v_cvt_pk_bf16_f32 v192, v192, v195
    ds_write_b32 v8, v192 offset:0
    s_waitcnt lgkmcnt(13)
    v_mfma_f32_32x32x16_bf16 v[64:79], v[132:135], v[100:103], v[64:79]
    v_cvt_pk_bf16_f32 v193, v193, v196
    ds_write_b32 v8, v193 offset:1024
    v_cvt_pk_bf16_f32 v194, v194, v197
    ds_write_b32 v8, v194 offset:2048
    s_waitcnt lgkmcnt(13)
    v_mfma_f32_32x32x16_bf16 v[32:47], v[136:139], v[104:107], v[32:47]
    v_mov_b32 v255, 1
    s_waitcnt lgkmcnt(0)
    s_mov_b64 exec, 1
    ds_write_b32 v30, v255
    s_mov_b64 exec, -1
    v_mfma_f32_32x32x16_bf16 v[48:63], v[140:143], v[104:107], v[48:63]
    v_add_f32 v160, v160, v161
    v_add_f32 v162, v162, v163
    v_mov_b32 v161, v160
    v_mov_b32 v163, v162
    v_mfma_f32_32x32x16_bf16 v[64:79], v[144:147], v[104:107], v[64:79]
    v_permlane32_swap_b32 v160, v161
    v_permlane32_swap_b32 v162, v163
    v_add_f32 v160, v160, v161
    v_add_f32 v162, v162, v163
    v_mfma_f32_32x32x16_bf16 v[32:47], v[148:151], v[108:111], v[32:47]
    ds_read_b128 v[4:7], v29 offset:16
    v_mul_f32 v160, 0x3b000000, v160
    v_mul_f32 v162, 0x3b000000, v162
    v_fma_f32 v162, -v160, v160, v162
    v_mfma_f32_32x32x16_bf16 v[48:63], v[152:155], v[108:111], v[48:63]
    s_waitcnt lgkmcnt(0)
C10:
    v_min3_u32 v4, v4, v5, v6
    v_min_u32 v4, v4, v7
    v_cmp_gt_u32 vcc, 1, v4
    s_cbranch_vccz C11
    ds_read_b128 v[4:7], v29 offset:16
    s_waitcnt lgkmcnt(0)
    s_branch C10
C11:
    ds_read_b128 v[168:171], v3 offset:0
    ds_read_b128 v[172:175], v3 offset:1024
    ds_read_b128 v[176:179], v3 offset:2048
    v_mfma_f32_32x32x16_bf16 v[64:79], v[156:159], v[108:111], v[64:79]
    v_max_f32 v162, 0, v162
    v_cvt_pk_bf16_f32 v190, v160, v162
    v_xor_b32 v191, 0x8000, v190
    v_perm_b32 v180, v191, v191, s65
    v_mov_b32 v181, v180
    v_mov_b32 v182, v180
    v_mov_b32 v183, v180
    v_lshlrev_b32 v184, 16, v190
    v_and_b32 v191, s73, v190
    v_add_f32 v191, 0x3727c5ac, v191
    v_cvt_pk_bf16_f32 v191, v191, v191
    v_lshlrev_b32 v191, 16, v191
    v_sqrt_f32 v191, v191
    s_nop 0
    v_cvt_pk_bf16_f32 v191, v191, v191
    v_lshlrev_b32 v186, 16, v191
    v_rcp_f32 v185, v186
    s_nop 0
    v_mul_f32 v188, 0xbfb8aa3b, v185
    ds_write_b64 v11, v[184:185]
    s_waitcnt lgkmcnt(3)
    v_mfma_f32_32x32x16_bf16 v[32:47], v[168:171], v[180:183], v[32:47]
    s_waitcnt lgkmcnt(2)
    v_mfma_f32_32x32x16_bf16 v[48:63], v[172:175], v[180:183], v[48:63]
    s_waitcnt lgkmcnt(1)
    v_mfma_f32_32x32x16_bf16 v[64:79], v[176:179], v[180:183], v[64:79]
    s_nop 7
    v_pk_mul_f32 v[144:145], v[32:33], v[188:189] op_sel_hi:[1,0]
    v_pk_mul_f32 v[146:147], v[34:35], v[188:189] op_sel_hi:[1,0]
    v_pk_mul_f32 v[148:149], v[36:37], v[188:189] op_sel_hi:[1,0]
    v_pk_mul_f32 v[150:151], v[38:39], v[188:189] op_sel_hi:[1,0]
    v_exp_f32 v144, v144
    v_exp_f32 v145, v145
    v_exp_f32 v146, v146
    v_exp_f32 v147, v147
    v_exp_f32 v148, v148
    v_exp_f32 v149, v149
    v_exp_f32 v150, v150
    v_exp_f32 v151, v151
    v_pk_fma_f32 v[144:145], v[144:145], v[186:187], v[186:187] op_sel_hi:[1,0,0]
    v_pk_fma_f32 v[146:147], v[146:147], v[186:187], v[186:187] op_sel_hi:[1,0,0]
    v_pk_fma_f32 v[148:149], v[148:149], v[186:187], v[186:187] op_sel_hi:[1,0,0]
    v_pk_fma_f32 v[150:151], v[150:151], v[186:187], v[186:187] op_sel_hi:[1,0,0]
    v_rcp_f32 v144, v144
    v_rcp_f32 v145, v145
    v_rcp_f32 v146, v146
    v_rcp_f32 v147, v147
    v_rcp_f32 v148, v148
    v_rcp_f32 v149, v149
    v_rcp_f32 v150, v150
    v_rcp_f32 v151, v151
    v_pk_mul_f32 v[144:145], v[144:145], v[32:33]
    v_pk_mul_f32 v[146:147], v[146:147], v[34:35]
    v_pk_mul_f32 v[148:149], v[148:149], v[36:37]
    v_pk_mul_f32 v[150:151], v[150:151], v[38:39]
    v_cvt_pk_bf16_f32 v168, v144, v145
    v_cvt_pk_bf16_f32 v169, v146, v147
    v_cvt_pk_bf16_f32 v170, v148, v149
    v_cvt_pk_bf16_f32 v171, v150, v151
    buffer_store_dwordx4 v[168:171], v2, s[36:39], s56 offen offset:0 sc1
    v_pk_mul_f32 v[152:153], v[40:41], v[188:189] op_sel_hi:[1,0]
    v_pk_mul_f32 v[154:155], v[42:43], v[188:189] op_sel_hi:[1,0]
    v_pk_mul_f32 v[156:157], v[44:45], v[188:189] op_sel_hi:[1,0]
    v_pk_mul_f32 v[158:159], v[46:47], v[188:189] op_sel_hi:[1,0]
    v_exp_f32 v152, v152
    v_exp_f32 v153, v153
    v_exp_f32 v154, v154
    v_exp_f32 v155, v155
    v_exp_f32 v156, v156
    v_exp_f32 v157, v157
    v_exp_f32 v158, v158
    v_exp_f32 v159, v159
    v_pk_fma_f32 v[152:153], v[152:153], v[186:187], v[186:187] op_sel_hi:[1,0,0]
    v_pk_fma_f32 v[154:155], v[154:155], v[186:187], v[186:187] op_sel_hi:[1,0,0]
    v_pk_fma_f32 v[156:157], v[156:157], v[186:187], v[186:187] op_sel_hi:[1,0,0]
    v_pk_fma_f32 v[158:159], v[158:159], v[186:187], v[186:187] op_sel_hi:[1,0,0]
    v_rcp_f32 v152, v152
    v_rcp_f32 v153, v153
    v_rcp_f32 v154, v154
    v_rcp_f32 v155, v155
    v_rcp_f32 v156, v156
    v_rcp_f32 v157, v157
    v_rcp_f32 v158, v158
    v_rcp_f32 v159, v159
    v_pk_mul_f32 v[152:153], v[152:153], v[40:41]
    v_pk_mul_f32 v[154:155], v[154:155], v[42:43]
    v_pk_mul_f32 v[156:157], v[156:157], v[44:45]
    v_pk_mul_f32 v[158:159], v[158:159], v[46:47]
    v_cvt_pk_bf16_f32 v172, v152, v153
    v_cvt_pk_bf16_f32 v173, v154, v155
    v_cvt_pk_bf16_f32 v174, v156, v157
    v_cvt_pk_bf16_f32 v175, v158, v159
    buffer_store_dwordx4 v[172:175], v2, s[36:39], s56 offen offset:1024 sc1
    v_pk_mul_f32 v[144:145], v[48:49], v[188:189] op_sel_hi:[1,0]
    v_pk_mul_f32 v[146:147], v[50:51], v[188:189] op_sel_hi:[1,0]
    v_pk_mul_f32 v[148:149], v[52:53], v[188:189] op_sel_hi:[1,0]
    v_pk_mul_f32 v[150:151], v[54:55], v[188:189] op_sel_hi:[1,0]
    v_exp_f32 v144, v144
    v_exp_f32 v145, v145
    v_exp_f32 v146, v146
    v_exp_f32 v147, v147
    v_exp_f32 v148, v148
    v_exp_f32 v149, v149
    v_exp_f32 v150, v150
    v_exp_f32 v151, v151
    v_pk_fma_f32 v[144:145], v[144:145], v[186:187], v[186:187] op_sel_hi:[1,0,0]
    v_pk_fma_f32 v[146:147], v[146:147], v[186:187], v[186:187] op_sel_hi:[1,0,0]
    v_pk_fma_f32 v[148:149], v[148:149], v[186:187], v[186:187] op_sel_hi:[1,0,0]
    v_pk_fma_f32 v[150:151], v[150:151], v[186:187], v[186:187] op_sel_hi:[1,0,0]
    v_rcp_f32 v144, v144
    v_rcp_f32 v145, v145
    v_rcp_f32 v146, v146
    v_rcp_f32 v147, v147
    v_rcp_f32 v148, v148
    v_rcp_f32 v149, v149
    v_rcp_f32 v150, v150
    v_rcp_f32 v151, v151
    v_pk_mul_f32 v[144:145], v[144:145], v[48:49]
    v_pk_mul_f32 v[146:147], v[146:147], v[50:51]
    v_pk_mul_f32 v[148:149], v[148:149], v[52:53]
    v_pk_mul_f32 v[150:151], v[150:151], v[54:55]
    v_cvt_pk_bf16_f32 v168, v144, v145
    v_cvt_pk_bf16_f32 v169, v146, v147
    v_cvt_pk_bf16_f32 v170, v148, v149
    v_cvt_pk_bf16_f32 v171, v150, v151
    buffer_store_dwordx4 v[168:171], v2, s[36:39], s56 offen offset:2048 sc1
    v_pk_mul_f32 v[152:153], v[56:57], v[188:189] op_sel_hi:[1,0]
    v_pk_mul_f32 v[154:155], v[58:59], v[188:189] op_sel_hi:[1,0]
    v_pk_mul_f32 v[156:157], v[60:61], v[188:189] op_sel_hi:[1,0]
    v_pk_mul_f32 v[158:159], v[62:63], v[188:189] op_sel_hi:[1,0]
    v_exp_f32 v152, v152
    v_exp_f32 v153, v153
    v_exp_f32 v154, v154
    v_exp_f32 v155, v155
    v_exp_f32 v156, v156
    v_exp_f32 v157, v157
    v_exp_f32 v158, v158
    v_exp_f32 v159, v159
    v_pk_fma_f32 v[152:153], v[152:153], v[186:187], v[186:187] op_sel_hi:[1,0,0]
    v_pk_fma_f32 v[154:155], v[154:155], v[186:187], v[186:187] op_sel_hi:[1,0,0]
    v_pk_fma_f32 v[156:157], v[156:157], v[186:187], v[186:187] op_sel_hi:[1,0,0]
    v_pk_fma_f32 v[158:159], v[158:159], v[186:187], v[186:187] op_sel_hi:[1,0,0]
    v_rcp_f32 v152, v152
    v_rcp_f32 v153, v153
    v_rcp_f32 v154, v154
    v_rcp_f32 v155, v155
    v_rcp_f32 v156, v156
    v_rcp_f32 v157, v157
    v_rcp_f32 v158, v158
    v_rcp_f32 v159, v159
    v_pk_mul_f32 v[152:153], v[152:153], v[56:57]
    v_pk_mul_f32 v[154:155], v[154:155], v[58:59]
    v_pk_mul_f32 v[156:157], v[156:157], v[60:61]
    v_pk_mul_f32 v[158:159], v[158:159], v[62:63]
    v_cvt_pk_bf16_f32 v172, v152, v153
    v_cvt_pk_bf16_f32 v173, v154, v155
    v_cvt_pk_bf16_f32 v174, v156, v157
    v_cvt_pk_bf16_f32 v175, v158, v159
    buffer_store_dwordx4 v[172:175], v2, s[36:39], s56 offen offset:3072 sc1
    v_pk_mul_f32 v[144:145], v[64:65], v[188:189] op_sel_hi:[1,0]
    v_pk_mul_f32 v[146:147], v[66:67], v[188:189] op_sel_hi:[1,0]
    v_pk_mul_f32 v[148:149], v[68:69], v[188:189] op_sel_hi:[1,0]
    v_pk_mul_f32 v[150:151], v[70:71], v[188:189] op_sel_hi:[1,0]
    v_exp_f32 v144, v144
    v_exp_f32 v145, v145
    v_exp_f32 v146, v146
    v_exp_f32 v147, v147
    v_exp_f32 v148, v148
    v_exp_f32 v149, v149
    v_exp_f32 v150, v150
    v_exp_f32 v151, v151
    v_pk_fma_f32 v[144:145], v[144:145], v[186:187], v[186:187] op_sel_hi:[1,0,0]
    v_pk_fma_f32 v[146:147], v[146:147], v[186:187], v[186:187] op_sel_hi:[1,0,0]
    v_pk_fma_f32 v[148:149], v[148:149], v[186:187], v[186:187] op_sel_hi:[1,0,0]
    v_pk_fma_f32 v[150:151], v[150:151], v[186:187], v[186:187] op_sel_hi:[1,0,0]
    ds_read_b128 v[4:7], v29 offset:0
    v_rcp_f32 v144, v144
    v_rcp_f32 v145, v145
    v_rcp_f32 v146, v146
    v_rcp_f32 v147, v147
    v_rcp_f32 v148, v148
    v_rcp_f32 v149, v149
    v_rcp_f32 v150, v150
    v_rcp_f32 v151, v151
    v_pk_mul_f32 v[144:145], v[144:145], v[64:65]
    v_pk_mul_f32 v[146:147], v[146:147], v[66:67]
    v_pk_mul_f32 v[148:149], v[148:149], v[68:69]
    v_pk_mul_f32 v[150:151], v[150:151], v[70:71]
    v_cvt_pk_bf16_f32 v168, v144, v145
    v_cvt_pk_bf16_f32 v169, v146, v147
    v_cvt_pk_bf16_f32 v170, v148, v149
    v_cvt_pk_bf16_f32 v171, v150, v151
    buffer_store_dwordx4 v[168:171], v2, s[36:39], s57 offen offset:0 sc1
    s_waitcnt lgkmcnt(0)
C12:
    v_min3_u32 v4, v4, v5, v6
    v_min_u32 v4, v4, v7
    v_cmp_gt_u32 vcc, 4, v4
    s_cbranch_vccz C13
    ds_read_b128 v[4:7], v29 offset:0
    s_waitcnt lgkmcnt(0)
    s_branch C12
C13:
    v_pk_mul_f32 v[152:153], v[72:73], v[188:189] op_sel_hi:[1,0]
    v_pk_mul_f32 v[154:155], v[74:75], v[188:189] op_sel_hi:[1,0]
    v_pk_mul_f32 v[156:157], v[76:77], v[188:189] op_sel_hi:[1,0]
    v_pk_mul_f32 v[158:159], v[78:79], v[188:189] op_sel_hi:[1,0]
    ds_read_b64 v[112:113], v217 offset:0
    ds_read_b64 v[114:115], v217 offset:8
    ds_read_b128 v[80:83], v216 offset:192
    ds_read_b128 v[84:87], v216 offset:704
    ds_read_b128 v[88:91], v216 offset:1216
    ds_read_b128 v[92:95], v216 offset:1728
    v_exp_f32 v152, v152
    v_exp_f32 v153, v153
    v_exp_f32 v154, v154
    v_exp_f32 v155, v155
    v_exp_f32 v156, v156
    v_exp_f32 v157, v157
    v_exp_f32 v158, v158
    v_exp_f32 v159, v159
    ds_read_b128 v[96:99], v216 offset:2240
    ds_read_b128 v[100:103], v216 offset:2752
    ds_read_b128 v[104:107], v216 offset:3264
    ds_read_b128 v[108:111], v216 offset:3776
    ds_read_b64 v[116:117], v217 offset:512
    ds_read_b64 v[118:119], v217 offset:520
    v_pk_fma_f32 v[152:153], v[152:153], v[186:187], v[186:187] op_sel_hi:[1,0,0]
    v_pk_fma_f32 v[154:155], v[154:155], v[186:187], v[186:187] op_sel_hi:[1,0,0]
    v_pk_fma_f32 v[156:157], v[156:157], v[186:187], v[186:187] op_sel_hi:[1,0,0]
    v_pk_fma_f32 v[158:159], v[158:159], v[186:187], v[186:187] op_sel_hi:[1,0,0]
    v_rcp_f32 v152, v152
    v_rcp_f32 v153, v153
    v_rcp_f32 v154, v154
    v_rcp_f32 v155, v155
    v_rcp_f32 v156, v156
    v_rcp_f32 v157, v157
    v_rcp_f32 v158, v158
    v_rcp_f32 v159, v159
    v_pk_mul_f32 v[152:153], v[152:153], v[72:73]
    v_pk_mul_f32 v[154:155], v[154:155], v[74:75]
    v_pk_mul_f32 v[156:157], v[156:157], v[76:77]
    v_pk_mul_f32 v[158:159], v[158:159], v[78:79]
    v_cvt_pk_bf16_f32 v172, v152, v153
    v_cvt_pk_bf16_f32 v173, v154, v155
    v_cvt_pk_bf16_f32 v174, v156, v157
    v_cvt_pk_bf16_f32 v175, v158, v159
    buffer_store_dwordx4 v[172:175], v2, s[36:39], s57 offen offset:1024 sc1
    s_waitcnt lgkmcnt(9)
    v_mfma_f32_16x16x32_bf16 v[160:163], v[80:83], v[112:115], 0
    ds_read_b64 v[120:121], v217 offset:1024
    ds_read_b64 v[122:123], v217 offset:1032
    s_waitcnt lgkmcnt(10)
    v_mfma_f32_16x16x32_bf16 v[164:167], v[84:87], v[112:115], 0
    ds_read_b64 v[124:125], v217 offset:1536
    ds_read_b64 v[126:127], v217 offset:1544
    s_waitcnt lgkmcnt(11)
    v_mfma_f32_16x16x32_bf16 v[168:171], v[88:91], v[112:115], 0
    ds_read_b64 v[128:129], v217 offset:2048
    ds_read_b64 v[130:131], v217 offset:2056
    s_waitcnt lgkmcnt(12)
    v_mfma_f32_16x16x32_bf16 v[172:175], v[92:95], v[112:115], 0
    ds_read_b64 v[132:133], v217 offset:2560
    ds_read_b64 v[134:135], v217 offset:2568
    s_waitcnt lgkmcnt(13)
    v_mfma_f32_16x16x32_bf16 v[176:179], v[96:99], v[112:115], 0
    ds_read_b64 v[136:137], v217 offset:3072
    ds_read_b64 v[138:139], v217 offset:3080
    s_waitcnt lgkmcnt(14)
    v_mfma_f32_16x16x32_bf16 v[180:183], v[100:103], v[112:115], 0
    ds_read_b64 v[140:141], v217 offset:3584
    ds_read_b64 v[142:143], v217 offset:3592
    s_waitcnt lgkmcnt(15)
    v_mfma_f32_16x16x32_bf16 v[184:187], v[104:107], v[112:115], 0
    ds_read_b64 v[64:65], v217 offset:64
    ds_read_b64 v[66:67], v217 offset:72
    s_waitcnt lgkmcnt(15)
    v_mfma_f32_16x16x32_bf16 v[188:191], v[108:111], v[112:115], 0
    ds_read_b128 v[32:35], v216 offset:128
    ds_read_b128 v[36:39], v216 offset:640
    s_waitcnt lgkmcnt(15)
    v_mfma_f32_16x16x32_bf16 v[164:167], v[80:83], v[116:119], v[164:167]
    ds_read_b128 v[40:43], v216 offset:1152
    v_mfma_f32_16x16x32_bf16 v[168:171], v[84:87], v[116:119], v[168:171]
    ds_read_b128 v[44:47], v216 offset:1664
    v_mfma_f32_16x16x32_bf16 v[172:175], v[88:91], v[116:119], v[172:175]
    ds_read_b128 v[48:51], v216 offset:2176
    v_mfma_f32_16x16x32_bf16 v[176:179], v[92:95], v[116:119], v[176:179]
    ds_read_b128 v[52:55], v216 offset:2688
    v_mfma_f32_16x16x32_bf16 v[180:183], v[96:99], v[116:119], v[180:183]
    ds_read_b128 v[56:59], v216 offset:3200
    v_mfma_f32_16x16x32_bf16 v[184:187], v[100:103], v[116:119], v[184:187]
    ds_read_b128 v[60:63], v216 offset:3712
    v_mfma_f32_16x16x32_bf16 v[188:191], v[104:107], v[116:119], v[188:191]
    ds_read_b64 v[68:69], v217 offset:576
    s_waitcnt lgkmcnt(15)
    v_mfma_f32_16x16x32_bf16 v[168:171], v[80:83], v[120:123], v[168:171]
    ds_read_b64 v[70:71], v217 offset:584
    v_mfma_f32_16x16x32_bf16 v[172:175], v[84:87], v[120:123], v[172:175]
    ds_read_b64 v[72:73], v217 offset:1088
    v_mfma_f32_16x16x32_bf16 v[176:179], v[88:91], v[120:123], v[176:179]
    ds_read_b64 v[74:75], v217 offset:1096
    v_mfma_f32_16x16x32_bf16 v[180:183], v[92:95], v[120:123], v[180:183]
    ds_read_b64 v[76:77], v217 offset:1600
    v_mfma_f32_16x16x32_bf16 v[184:187], v[96:99], v[120:123], v[184:187]
    ds_read_b64 v[78:79], v217 offset:1608
    v_mfma_f32_16x16x32_bf16 v[188:191], v[100:103], v[120:123], v[188:191]
    ds_read_b64 v[144:145], v217 offset:2112
    v_mfma_f32_16x16x32_bf16 v[172:175], v[80:83], v[124:127], v[172:175]
    ds_read_b64 v[146:147], v217 offset:2120
    v_mfma_f32_16x16x32_bf16 v[176:179], v[84:87], v[124:127], v[176:179]
    ds_read_b64 v[148:149], v217 offset:2624
    v_mfma_f32_16x16x32_bf16 v[180:183], v[88:91], v[124:127], v[180:183]
    ds_read_b64 v[150:151], v217 offset:2632
    v_mfma_f32_16x16x32_bf16 v[184:187], v[92:95], v[124:127], v[184:187]
    ds_read_b64 v[152:153], v217 offset:3136
    v_mfma_f32_16x16x32_bf16 v[188:191], v[96:99], v[124:127], v[188:191]
    ds_read_b64 v[154:155], v217 offset:3144
    v_mfma_f32_16x16x32_bf16 v[176:179], v[80:83], v[128:131], v[176:179]
    ds_read_b64 v[156:157], v217 offset:3648
    v_mfma_f32_16x16x32_bf16 v[180:183], v[84:87], v[128:131], v[180:183]
    ds_read_b64 v[158:159], v217 offset:3656
    v_mfma_f32_16x16x32_bf16 v[184:187], v[88:91], v[128:131], v[184:187]
    v_mfma_f32_16x16x32_bf16 v[188:191], v[92:95], v[128:131], v[188:191]
    v_mfma_f32_16x16x32_bf16 v[180:183], v[80:83], v[132:135], v[180:183]
    v_mfma_f32_16x16x32_bf16 v[184:187], v[84:87], v[132:135], v[184:187]
    v_mfma_f32_16x16x32_bf16 v[188:191], v[88:91], v[132:135], v[188:191]
    s_waitcnt lgkmcnt(15)
    v_mfma_f32_16x16x32_bf16 v[184:187], v[80:83], v[136:139], v[184:187]
    v_mfma_f32_16x16x32_bf16 v[188:191], v[84:87], v[136:139], v[188:191]
    v_mfma_f32_16x16x32_bf16 v[188:191], v[80:83], v[140:143], v[188:191]
    v_mfma_f32_16x16x32_bf16 v[160:163], v[32:35], v[64:67], v[160:163]
    ds_read_b64 v[112:113], v217 offset:128
    v_mfma_f32_16x16x32_bf16 v[164:167], v[36:39], v[64:67], v[164:167]
    ds_read_b64 v[114:115], v217 offset:136
    v_mfma_f32_16x16x32_bf16 v[168:171], v[40:43], v[64:67], v[168:171]
    ds_read_b128 v[80:83], v216 offset:64
    v_mfma_f32_16x16x32_bf16 v[172:175], v[44:47], v[64:67], v[172:175]
    ds_read_b128 v[84:87], v216 offset:576
    v_mfma_f32_16x16x32_bf16 v[176:179], v[48:51], v[64:67], v[176:179]
    ds_read_b128 v[88:91], v216 offset:1088
    v_mfma_f32_16x16x32_bf16 v[180:183], v[52:55], v[64:67], v[180:183]
    ds_read_b128 v[92:95], v216 offset:1600
    v_mfma_f32_16x16x32_bf16 v[184:187], v[56:59], v[64:67], v[184:187]
    ds_read_b128 v[96:99], v216 offset:2112
    s_waitcnt lgkmcnt(15)
    v_mfma_f32_16x16x32_bf16 v[188:191], v[60:63], v[64:67], v[188:191]
    ds_read_b128 v[100:103], v216 offset:2624
    v_mfma_f32_16x16x32_bf16 v[164:167], v[32:35], v[68:71], v[164:167]
    ds_read_b128 v[104:107], v216 offset:3136
    v_mfma_f32_16x16x32_bf16 v[168:171], v[36:39], v[68:71], v[168:171]
    ds_read_b128 v[108:111], v216 offset:3648
    v_mfma_f32_16x16x32_bf16 v[172:175], v[40:43], v[68:71], v[172:175]
    ds_read_b64 v[116:117], v217 offset:640
    v_mfma_f32_16x16x32_bf16 v[176:179], v[44:47], v[68:71], v[176:179]
    ds_read_b64 v[118:119], v217 offset:648
    v_mfma_f32_16x16x32_bf16 v[180:183], v[48:51], v[68:71], v[180:183]
    ds_read_b64 v[120:121], v217 offset:1152
    v_mfma_f32_16x16x32_bf16 v[184:187], v[52:55], v[68:71], v[184:187]
    ds_read_b64 v[122:123], v217 offset:1160
    s_waitcnt vmcnt(0)
    s_mov_b32 s82, 131072
    s_mov_b64 exec, 0xffff
    buffer_store_dwordx2 v[252:253], v28, s[36:39], s82 offen sc1
    s_mov_b64 exec, -1
    v_mov_b32 v255, 2
    s_mov_b64 exec, 1
    ds_write_b32 v30, v255
    s_mov_b64 exec, -1
    v_mfma_f32_16x16x32_bf16 v[188:191], v[56:59], v[68:71], v[188:191]
    ds_read_b64 v[124:125], v217 offset:1664
    v_mfma_f32_16x16x32_bf16 v[168:171], v[32:35], v[72:75], v[168:171]
    ds_read_b64 v[126:127], v217 offset:1672
    v_mfma_f32_16x16x32_bf16 v[172:175], v[36:39], v[72:75], v[172:175]
    ds_read_b64 v[128:129], v217 offset:2176
    v_mfma_f32_16x16x32_bf16 v[176:179], v[40:43], v[72:75], v[176:179]
    ds_read_b64 v[130:131], v217 offset:2184
    v_mfma_f32_16x16x32_bf16 v[180:183], v[44:47], v[72:75], v[180:183]
    ds_read_b64 v[132:133], v217 offset:2688
    v_mfma_f32_16x16x32_bf16 v[184:187], v[48:51], v[72:75], v[184:187]
    ds_read_b64 v[134:135], v217 offset:2696
    v_mfma_f32_16x16x32_bf16 v[188:191], v[52:55], v[72:75], v[188:191]
    ds_read_b64 v[136:137], v217 offset:3200
    v_mfma_f32_16x16x32_bf16 v[172:175], v[32:35], v[76:79], v[172:175]
    ds_read_b64 v[138:139], v217 offset:3208
    v_mfma_f32_16x16x32_bf16 v[176:179], v[36:39], v[76:79], v[176:179]
    ds_read_b64 v[140:141], v217 offset:3712
    v_mfma_f32_16x16x32_bf16 v[180:183], v[40:43], v[76:79], v[180:183]
    ds_read_b64 v[142:143], v217 offset:3720
    v_mfma_f32_16x16x32_bf16 v[184:187], v[44:47], v[76:79], v[184:187]
    v_mfma_f32_16x16x32_bf16 v[188:191], v[48:51], v[76:79], v[188:191]
    s_waitcnt lgkmcnt(15)
    v_mfma_f32_16x16x32_bf16 v[176:179], v[32:35], v[144:147], v[176:179]
    v_mfma_f32_16x16x32_bf16 v[180:183], v[36:39], v[144:147], v[180:183]
    v_mfma_f32_16x16x32_bf16 v[184:187], v[40:43], v[144:147], v[184:187]
    v_mfma_f32_16x16x32_bf16 v[188:191], v[44:47], v[144:147], v[188:191]
    v_mfma_f32_16x16x32_bf16 v[180:183], v[32:35], v[148:151], v[180:183]
    v_mfma_f32_16x16x32_bf16 v[184:187], v[36:39], v[148:151], v[184:187]
    v_mfma_f32_16x16x32_bf16 v[188:191], v[40:43], v[148:151], v[188:191]
    v_mfma_f32_16x16x32_bf16 v[184:187], v[32:35], v[152:155], v[184:187]
    v_mfma_f32_16x16x32_bf16 v[188:191], v[36:39], v[152:155], v[188:191]
    v_mfma_f32_16x16x32_bf16 v[188:191], v[32:35], v[156:159], v[188:191]
    v_mfma_f32_16x16x32_bf16 v[160:163], v[80:83], v[112:115], v[160:163]
    ds_read_b64 v[64:65], v217 offset:192
    v_mfma_f32_16x16x32_bf16 v[164:167], v[84:87], v[112:115], v[164:167]
    ds_read_b64 v[66:67], v217 offset:200
    v_mfma_f32_16x16x32_bf16 v[168:171], v[88:91], v[112:115], v[168:171]
    ds_read_b128 v[32:35], v216 offset:0
    v_mfma_f32_16x16x32_bf16 v[172:175], v[92:95], v[112:115], v[172:175]
    ds_read_b128 v[36:39], v216 offset:512
    v_mfma_f32_16x16x32_bf16 v[176:179], v[96:99], v[112:115], v[176:179]
    ds_read_b128 v[40:43], v216 offset:1024
    v_mfma_f32_16x16x32_bf16 v[180:183], v[100:103], v[112:115], v[180:183]
    ds_read_b128 v[44:47], v216 offset:1536
    v_mfma_f32_16x16x32_bf16 v[184:187], v[104:107], v[112:115], v[184:187]
    ds_read_b128 v[48:51], v216 offset:2048
    v_mfma_f32_16x16x32_bf16 v[188:191], v[108:111], v[112:115], v[188:191]
    ds_read_b128 v[52:55], v216 offset:2560
    s_waitcnt lgkmcnt(15)
    v_mfma_f32_16x16x32_bf16 v[164:167], v[80:83], v[116:119], v[164:167]
    ds_read_b128 v[56:59], v216 offset:3072
    v_mfma_f32_16x16x32_bf16 v[168:171], v[84:87], v[116:119], v[168:171]
    ds_read_b128 v[60:63], v216 offset:3584
    v_mfma_f32_16x16x32_bf16 v[172:175], v[88:91], v[116:119], v[172:175]
    ds_read_b64 v[68:69], v217 offset:704
    v_mfma_f32_16x16x32_bf16 v[176:179], v[92:95], v[116:119], v[176:179]
    ds_read_b64 v[70:71], v217 offset:712
    v_mfma_f32_16x16x32_bf16 v[180:183], v[96:99], v[116:119], v[180:183]
    ds_read_b64 v[72:73], v217 offset:1216
    v_mfma_f32_16x16x32_bf16 v[184:187], v[100:103], v[116:119], v[184:187]
    ds_read_b64 v[74:75], v217 offset:1224
    v_mfma_f32_16x16x32_bf16 v[188:191], v[104:107], v[116:119], v[188:191]
    ds_read_b64 v[76:77], v217 offset:1728
    v_mfma_f32_16x16x32_bf16 v[168:171], v[80:83], v[120:123], v[168:171]
    ds_read_b64 v[78:79], v217 offset:1736
    v_mfma_f32_16x16x32_bf16 v[172:175], v[84:87], v[120:123], v[172:175]
    ds_read_b64 v[144:145], v217 offset:2240
    v_mfma_f32_16x16x32_bf16 v[176:179], v[88:91], v[120:123], v[176:179]
    ds_read_b64 v[146:147], v217 offset:2248
    v_mfma_f32_16x16x32_bf16 v[180:183], v[92:95], v[120:123], v[180:183]
    ds_read_b64 v[148:149], v217 offset:2752
    v_mfma_f32_16x16x32_bf16 v[184:187], v[96:99], v[120:123], v[184:187]
    ds_read_b64 v[150:151], v217 offset:2760
    v_mfma_f32_16x16x32_bf16 v[188:191], v[100:103], v[120:123], v[188:191]
    ds_read_b64 v[152:153], v217 offset:3264
    v_mfma_f32_16x16x32_bf16 v[172:175], v[80:83], v[124:127], v[172:175]
    ds_read_b64 v[154:155], v217 offset:3272
    v_mfma_f32_16x16x32_bf16 v[176:179], v[84:87], v[124:127], v[176:179]
    ds_read_b64 v[156:157], v217 offset:3776
    v_mfma_f32_16x16x32_bf16 v[180:183], v[88:91], v[124:127], v[180:183]
    ds_read_b64 v[158:159], v217 offset:3784
    v_mfma_f32_16x16x32_bf16 v[184:187], v[92:95], v[124:127], v[184:187]
    v_mfma_f32_16x16x32_bf16 v[188:191], v[96:99], v[124:127], v[188:191]
    s_waitcnt lgkmcnt(15)
    v_mfma_f32_16x16x32_bf16 v[176:179], v[80:83], v[128:131], v[176:179]
    v_mov_b32 v255, 3
    s_waitcnt lgkmcnt(0)
    s_mov_b64 exec, 1
    ds_write_b32 v30, v255
    s_mov_b64 exec, -1
    v_mfma_f32_16x16x32_bf16 v[180:183], v[84:87], v[128:131], v[180:183]
    v_mfma_f32_16x16x32_bf16 v[184:187], v[88:91], v[128:131], v[184:187]
    v_mfma_f32_16x16x32_bf16 v[188:191], v[92:95], v[128:131], v[188:191]
    v_mfma_f32_16x16x32_bf16 v[180:183], v[80:83], v[132:135], v[180:183]
    v_mfma_f32_16x16x32_bf16 v[184:187], v[84:87], v[132:135], v[184:187]
    v_mfma_f32_16x16x32_bf16 v[188:191], v[88:91], v[132:135], v[188:191]
    ds_read_b128 v[4:7], v29 offset:16
    v_mfma_f32_16x16x32_bf16 v[184:187], v[80:83], v[136:139], v[184:187]
    v_mfma_f32_16x16x32_bf16 v[188:191], v[84:87], v[136:139], v[188:191]
    v_mfma_f32_16x16x32_bf16 v[188:191], v[80:83], v[140:143], v[188:191]
    v_mfma_f32_16x16x32_bf16 v[160:163], v[32:35], v[64:67], v[160:163]
    v_mfma_f32_16x16x32_bf16 v[164:167], v[36:39], v[64:67], v[164:167]
    v_mfma_f32_16x16x32_bf16 v[164:167], v[32:35], v[68:71], v[164:167]
    s_waitcnt lgkmcnt(0)
C14:
    v_min3_u32 v4, v4, v5, v6
    v_min_u32 v4, v4, v7
    v_cmp_gt_u32 vcc, 3, v4
    s_cbranch_vccz C15
    ds_read_b128 v[4:7], v29 offset:16
    s_waitcnt lgkmcnt(0)
    s_branch C14
C15:
    v_mfma_f32_16x16x32_bf16 v[168:171], v[40:43], v[64:67], v[168:171]
    v_mfma_f32_16x16x32_bf16 v[168:171], v[36:39], v[68:71], v[168:171]
    v_mfma_f32_16x16x32_bf16 v[168:171], v[32:35], v[72:75], v[168:171]
    v_mfma_f32_16x16x32_bf16 v[172:175], v[44:47], v[64:67], v[172:175]
    v_mfma_f32_16x16x32_bf16 v[172:175], v[40:43], v[68:71], v[172:175]
    ds_write_b128 v219, v[160:163] offset:0
    v_mfma_f32_16x16x32_bf16 v[172:175], v[36:39], v[72:75], v[172:175]
    v_mfma_f32_16x16x32_bf16 v[172:175], v[32:35], v[76:79], v[172:175]
    v_mfma_f32_16x16x32_bf16 v[176:179], v[48:51], v[64:67], v[176:179]
    v_mfma_f32_16x16x32_bf16 v[176:179], v[44:47], v[68:71], v[176:179]
    ds_write_b128 v219, v[164:167] offset:1024
    v_mfma_f32_16x16x32_bf16 v[176:179], v[40:43], v[72:75], v[176:179]
    v_mfma_f32_16x16x32_bf16 v[176:179], v[36:39], v[76:79], v[176:179]
    v_mfma_f32_16x16x32_bf16 v[176:179], v[32:35], v[144:147], v[176:179]
    v_mfma_f32_16x16x32_bf16 v[180:183], v[52:55], v[64:67], v[180:183]
    ds_write_b128 v219, v[168:171] offset:2048
    v_mfma_f32_16x16x32_bf16 v[180:183], v[48:51], v[68:71], v[180:183]
    v_mfma_f32_16x16x32_bf16 v[180:183], v[44:47], v[72:75], v[180:183]
    v_mfma_f32_16x16x32_bf16 v[180:183], v[40:43], v[76:79], v[180:183]
    v_mfma_f32_16x16x32_bf16 v[180:183], v[36:39], v[144:147], v[180:183]
    ds_write_b128 v219, v[172:175] offset:3072
    v_mfma_f32_16x16x32_bf16 v[180:183], v[32:35], v[148:151], v[180:183]
    v_mfma_f32_16x16x32_bf16 v[184:187], v[56:59], v[64:67], v[184:187]
    v_mfma_f32_16x16x32_bf16 v[184:187], v[52:55], v[68:71], v[184:187]
    v_mfma_f32_16x16x32_bf16 v[184:187], v[48:51], v[72:75], v[184:187]
    ds_write_b128 v219, v[176:179] offset:4096
    v_mfma_f32_16x16x32_bf16 v[184:187], v[44:47], v[76:79], v[184:187]
    v_mfma_f32_16x16x32_bf16 v[184:187], v[40:43], v[144:147], v[184:187]
    v_mfma_f32_16x16x32_bf16 v[184:187], v[36:39], v[148:151], v[184:187]
    v_mfma_f32_16x16x32_bf16 v[184:187], v[32:35], v[152:155], v[184:187]
    ds_write_b128 v219, v[180:183] offset:5120
    v_mfma_f32_16x16x32_bf16 v[188:191], v[60:63], v[64:67], v[188:191]
    v_mfma_f32_16x16x32_bf16 v[188:191], v[56:59], v[68:71], v[188:191]
    v_mfma_f32_16x16x32_bf16 v[188:191], v[52:55], v[72:75], v[188:191]
    v_mfma_f32_16x16x32_bf16 v[188:191], v[48:51], v[76:79], v[188:191]
    v_mfma_f32_16x16x32_bf16 v[188:191], v[44:47], v[144:147], v[188:191]
    v_mfma_f32_16x16x32_bf16 v[188:191], v[40:43], v[148:151], v[188:191]
    v_mfma_f32_16x16x32_bf16 v[188:191], v[36:39], v[152:155], v[188:191]
    v_mfma_f32_16x16x32_bf16 v[188:191], v[32:35], v[156:159], v[188:191]
    ds_write_b128 v219, v[184:187] offset:6144
    s_nop 6
    ds_write_b128 v219, v[188:191] offset:7168
    ds_read_b128 v[4:7], v29 offset:0
    v_mov_b32 v255, 4
    s_waitcnt lgkmcnt(0)
    s_mov_b64 exec, 1
    ds_write_b32 v30, v255
    s_mov_b64 exec, -1
C16:
    v_min3_u32 v4, v4, v5, v6
    v_min_u32 v4, v4, v7
    v_cmp_gt_u32 vcc, 5, v4
    s_cbranch_vccz C17
    ds_read_b128 v[4:7], v29 offset:0
    s_waitcnt lgkmcnt(0)
    s_branch C16
C17:
    s_add_u32 s80, s59, 0
    buffer_load_dwordx4 v[80:83], v2, s[36:39], s80 offen offset:0 sc1
    buffer_load_dwordx4 v[84:87], v2, s[36:39], s80 offen offset:1024 sc1
    buffer_load_dwordx4 v[88:91], v2, s[36:39], s80 offen offset:2048 sc1
    buffer_load_dwordx4 v[92:95], v2, s[36:39], s80 offen offset:3072 sc1
    s_add_u32 s80, s59, 4096
    buffer_load_dwordx4 v[96:99], v2, s[36:39], s80 offen offset:0 sc1
    ds_read_b128 v[4:7], v29 offset:0
    buffer_load_dwordx4 v[100:103], v2, s[36:39], s80 offen offset:1024 sc1
    buffer_load_dwordx4 v[104:107], v2, s[36:39], s80 offen offset:2048 sc1
    s_waitcnt lgkmcnt(0)
C18:
    v_min3_u32 v4, v4, v5, v6
    v_min_u32 v4, v4, v7
    v_cmp_gt_u32 vcc, 6, v4
    s_cbranch_vccz C19
    ds_read_b128 v[4:7], v29 offset:0
    s_waitcnt lgkmcnt(0)
    s_branch C18
C19:
    buffer_load_dwordx4 v[108:111], v2, s[36:39], s80 offen offset:3072 sc1
    ds_read_b64_tr_b16 v[68:69], v235 offset:0
    ds_read_b64_tr_b16 v[70:71], v235 offset:1024
    ds_read_b64_tr_b16 v[64:65], v234 offset:0
    ds_read_b64_tr_b16 v[66:67], v234 offset:1024
    ds_read_b64_tr_b16 v[76:77], v235 offset:4096
    ds_read_b64_tr_b16 v[78:79], v235 offset:5120
    ds_read_b64_tr_b16 v[72:73], v234 offset:4096
    ds_read_b64_tr_b16 v[74:75], v234 offset:5120
    ds_read_b64_tr_b16 v[148:149], v235 offset:8192
    ds_read_b64_tr_b16 v[150:151], v235 offset:9216
    ds_read_b64_tr_b16 v[144:145], v234 offset:8192
    s_add_u32 s80, s59, 8192
    buffer_load_dwordx4 v[112:115], v2, s[36:39], s80 offen offset:0 sc1
    ds_read_b64_tr_b16 v[146:147], v234 offset:9216
    ds_read_b64_tr_b16 v[16:17], v235 offset:12288
    ds_read_b64_tr_b16 v[18:19], v235 offset:13312
    ds_read_b64_tr_b16 v[12:13], v234 offset:12288
    ds_read_b64_tr_b16 v[14:15], v234 offset:13312
    s_waitcnt vmcnt(8) lgkmcnt(12)
    v_mfma_f32_32x32x16_bf16 v[48:63], v[68:71], v[80:83], 0
    ds_read_b64_tr_b16 v[24:25], v235 offset:16384
    ds_read_b64_tr_b16 v[26:27], v235 offset:17408
    v_mfma_f32_32x32x16_bf16 v[32:47], v[64:67], v[80:83], 0
    buffer_load_dwordx4 v[116:119], v2, s[36:39], s80 offen offset:1024 sc1
    ds_read_b64_tr_b16 v[20:21], v234 offset:16384
    ds_read_b64_tr_b16 v[22:23], v234 offset:17408
    s_waitcnt vmcnt(8) lgkmcnt(12)
    v_mfma_f32_32x32x16_bf16 v[48:63], v[76:79], v[84:87], v[48:63]
    ds_read_b64_tr_b16 v[68:69], v235 offset:20480
    ds_read_b64_tr_b16 v[70:71], v235 offset:21504
    v_mfma_f32_32x32x16_bf16 v[32:47], v[72:75], v[84:87], v[32:47]
    buffer_load_dwordx4 v[120:123], v2, s[36:39], s80 offen offset:2048 sc1
    ds_read_b64_tr_b16 v[64:65], v234 offset:20480
    ds_read_b64_tr_b16 v[66:67], v234 offset:21504
    s_waitcnt vmcnt(8) lgkmcnt(12)
    v_mfma_f32_32x32x16_bf16 v[48:63], v[148:151], v[88:91], v[48:63]
    ds_read_b64_tr_b16 v[76:77], v235 offset:24576
    ds_read_b64_tr_b16 v[78:79], v235 offset:25600
    ds_read_b64_tr_b16 v[72:73], v234 offset:24576
    ds_read_b64_tr_b16 v[74:75], v234 offset:25600
    v_mfma_f32_32x32x16_bf16 v[32:47], v[144:147], v[88:91], v[32:47]
    buffer_load_dwordx4 v[124:127], v2, s[36:39], s80 offen offset:3072 sc1
    ds_read_b128 v[152:155], v224
    ds_read_b128 v[156:159], v225
    ds_read_b64 v[232:233], v226
    s_waitcnt vmcnt(8) lgkmcnt(15)
    v_mfma_f32_32x32x16_bf16 v[48:63], v[16:19], v[92:95], v[48:63]
    ds_read_b64_tr_b16 v[148:149], v235 offset:28672
    ds_read_b64_tr_b16 v[150:151], v235 offset:29696
    v_mfma_f32_32x32x16_bf16 v[32:47], v[12:15], v[92:95], v[32:47]
    s_add_u32 s80, s59, 12288
    buffer_load_dwordx4 v[128:131], v2, s[36:39], s80 offen offset:0 sc1
    ds_read_b64_tr_b16 v[144:145], v234 offset:28672
    ds_read_b64_tr_b16 v[146:147], v234 offset:29696
    s_waitcnt vmcnt(8) lgkmcnt(15)
    v_mfma_f32_32x32x16_bf16 v[48:63], v[24:27], v[96:99], v[48:63]
    ds_read_b64_tr_b16 v[16:17], v235 offset:32768
    ds_read_b64_tr_b16 v[18:19], v235 offset:33792
    s_waitcnt lgkmcnt(8)
    v_lshlrev_b32 v160, 16, v152
    v_mfma_f32_32x32x16_bf16 v[32:47], v[20:23], v[96:99], v[32:47]
    buffer_load_dwordx4 v[132:135], v2, s[36:39], s80 offen offset:1024 sc1
    ds_read_b64_tr_b16 v[12:13], v234 offset:32768
    ds_read_b64_tr_b16 v[14:15], v234 offset:33792
    v_and_b32 v161, s73, v152
    s_waitcnt vmcnt(8)
    v_mfma_f32_32x32x16_bf16 v[48:63], v[68:71], v[100:103], v[48:63]
    ds_read_b64_tr_b16 v[24:25], v235 offset:36864
    ds_read_b64_tr_b16 v[26:27], v235 offset:37888
    v_lshlrev_b32 v162, 16, v153
    v_and_b32 v163, s73, v153
    v_mfma_f32_32x32x16_bf16 v[32:47], v[64:67], v[100:103], v[32:47]
    buffer_load_dwordx4 v[136:139], v2, s[36:39], s80 offen offset:2048 sc1
    ds_read_b64_tr_b16 v[20:21], v234 offset:36864
    ds_read_b64_tr_b16 v[22:23], v234 offset:37888
    v_lshlrev_b32 v164, 16, v154
    s_waitcnt vmcnt(8)
    v_mfma_f32_32x32x16_bf16 v[48:63], v[76:79], v[104:107], v[48:63]
    ds_read_b64_tr_b16 v[68:69], v235 offset:40960
    ds_read_b64_tr_b16 v[70:71], v235 offset:41984
    v_and_b32 v165, s73, v154
    v_lshlrev_b32 v166, 16, v155
    v_mfma_f32_32x32x16_bf16 v[32:47], v[72:75], v[104:107], v[32:47]
    buffer_load_dwordx4 v[140:143], v2, s[36:39], s80 offen offset:3072 sc1
    ds_read_b64_tr_b16 v[64:65], v234 offset:40960
    ds_read_b64_tr_b16 v[66:67], v234 offset:41984
    v_and_b32 v167, s73, v155
    s_waitcnt vmcnt(8) lgkmcnt(12)
    v_mfma_f32_32x32x16_bf16 v[48:63], v[148:151], v[108:111], v[48:63]
    ds_read_b64_tr_b16 v[76:77], v235 offset:45056
    ds_read_b64_tr_b16 v[78:79], v235 offset:46080
    v_lshlrev_b32 v168, 16, v156
    v_and_b32 v169, s73, v156
    v_mfma_f32_32x32x16_bf16 v[32:47], v[144:147], v[108:111], v[32:47]
    s_add_u32 s80, s59, 16384
    buffer_load_dwordx4 v[240:243], v2, s[36:39], s80 offen offset:0 sc1
    ds_read_b64_tr_b16 v[72:73], v234 offset:45056
    ds_read_b64_tr_b16 v[74:75], v234 offset:46080
    s_waitcnt vmcnt(8) lgkmcnt(12)
    v_mfma_f32_32x32x16_bf16 v[48:63], v[16:19], v[112:115], v[48:63]
    ds_read_b64_tr_b16 v[148:149], v235 offset:49152
    ds_read_b64_tr_b16 v[150:151], v235 offset:50176
    v_lshlrev_b32 v170, 16, v157
    v_and_b32 v171, s73, v157
    v_mfma_f32_32x32x16_bf16 v[32:47], v[12:15], v[112:115], v[32:47]
    buffer_load_dwordx4 v[244:247], v2, s[36:39], s80 offen offset:1024 sc1
    ds_read_b64_tr_b16 v[144:145], v234 offset:49152
    ds_read_b64_tr_b16 v[146:147], v234 offset:50176
    v_lshlrev_b32 v172, 16, v158
    s_waitcnt vmcnt(8) lgkmcnt(12)
    v_mfma_f32_32x32x16_bf16 v[48:63], v[24:27], v[116:119], v[48:63]
    ds_read_b64_tr_b16 v[16:17], v235 offset:53248
    ds_read_b64_tr_b16 v[18:19], v235 offset:54272
    v_and_b32 v173, s73, v158
    v_lshlrev_b32 v174, 16, v159
    v_mfma_f32_32x32x16_bf16 v[32:47], v[20:23], v[116:119], v[32:47]
    buffer_load_dwordx4 v[248:251], v2, s[36:39], s80 offen offset:2048 sc1
    ds_read_b64_tr_b16 v[12:13], v234 offset:53248
    ds_read_b64_tr_b16 v[14:15], v234 offset:54272
    v_mov_b32 v255, 6
    s_mov_b64 exec, 1
    ds_write_b32 v30, v255
    s_mov_b64 exec, -1
    s_waitcnt vmcnt(8) lgkmcnt(13)
    v_mfma_f32_32x32x16_bf16 v[48:63], v[68:71], v[120:123], v[48:63]
    ds_read_b64_tr_b16 v[24:25], v235 offset:57344
    ds_read_b64_tr_b16 v[26:27], v235 offset:58368
    buffer_load_dwordx4 v[80:83], v2, s[36:39], s80 offen offset:3072 sc1
    v_and_b32 v175, s73, v159
    v_mfma_f32_32x32x16_bf16 v[32:47], v[64:67], v[120:123], v[32:47]
    ds_read_b64_tr_b16 v[20:21], v234 offset:57344
    ds_read_b64_tr_b16 v[22:23], v234 offset:58368
    v_sub_f32 v176, v160, v232
    v_sub_f32 v177, v161, v232
    s_waitcnt vmcnt(8) lgkmcnt(13)
    v_mfma_f32_32x32x16_bf16 v[48:63], v[76:79], v[124:127], v[48:63]
    s_add_u32 s80, s59, 20480
    buffer_load_dwordx4 v[84:87], v2, s[36:39], s80 offen offset:0 sc1
    ds_read_b64_tr_b16 v[68:69], v237 offset:0
    ds_read_b64_tr_b16 v[70:71], v237 offset:1024
    v_mfma_f32_32x32x16_bf16 v[32:47], v[72:75], v[124:127], v[32:47]
    ds_read_b64_tr_b16 v[64:65], v236 offset:0
    ds_read_b64_tr_b16 v[66:67], v236 offset:1024
    v_sub_f32 v178, v162, v232
    v_sub_f32 v179, v163, v232
    s_waitcnt vmcnt(8) lgkmcnt(13)
    v_mfma_f32_32x32x16_bf16 v[48:63], v[148:151], v[128:131], v[48:63]
    buffer_load_dwordx4 v[88:91], v2, s[36:39], s80 offen offset:1024 sc1
    ds_read_b64_tr_b16 v[76:77], v237 offset:4096
    ds_read_b64_tr_b16 v[78:79], v237 offset:5120
    v_sub_f32 v180, v164, v232
    v_mfma_f32_32x32x16_bf16 v[32:47], v[144:147], v[128:131], v[32:47]
    ds_read_b64_tr_b16 v[72:73], v236 offset:4096
    ds_read_b64_tr_b16 v[74:75], v236 offset:5120
    v_sub_f32 v181, v165, v232
    v_sub_f32 v182, v166, v232
    s_waitcnt vmcnt(8) lgkmcnt(13)
    buffer_load_dwordx4 v[92:95], v2, s[36:39], s80 offen offset:2048 sc1
    v_mfma_f32_32x32x16_bf16 v[48:63], v[16:19], v[132:135], v[48:63]
    ds_read_b64_tr_b16 v[148:149], v237 offset:8192
    ds_read_b64_tr_b16 v[150:151], v237 offset:9216
    v_sub_f32 v183, v167, v232
    v_sub_f32 v184, v168, v232
    v_mfma_f32_32x32x16_bf16 v[32:47], v[12:15], v[132:135], v[32:47]
    ds_read_b64_tr_b16 v[144:145], v236 offset:8192
    ds_read_b64_tr_b16 v[146:147], v236 offset:9216
    buffer_load_dwordx4 v[96:99], v2, s[36:39], s80 offen offset:3072 sc1
    v_sub_f32 v185, v169, v232
    s_waitcnt vmcnt(9) lgkmcnt(12)
    v_mfma_f32_32x32x16_bf16 v[48:63], v[24:27], v[136:139], v[48:63]
    ds_read_b64_tr_b16 v[16:17], v237 offset:12288
    ds_read_b64_tr_b16 v[18:19], v237 offset:13312
    v_sub_f32 v186, v170, v232
    v_sub_f32 v187, v171, v232
    v_mfma_f32_32x32x16_bf16 v[32:47], v[20:23], v[136:139], v[32:47]
    s_add_u32 s80, s59, 24576
    buffer_load_dwordx4 v[100:103], v2, s[36:39], s80 offen offset:0 sc1
    ds_read_b64_tr_b16 v[12:13], v236 offset:12288
    ds_read_b64_tr_b16 v[14:15], v236 offset:13312
    s_waitcnt vmcnt(9) lgkmcnt(12)
    v_mfma_f32_32x32x16_bf16 v[48:63], v[68:71], v[140:143], v[48:63]
    ds_read_b64_tr_b16 v[24:25], v237 offset:16384
    ds_read_b64_tr_b16 v[26:27], v237 offset:17408
    v_sub_f32 v188, v172, v232
    v_sub_f32 v189, v173, v232
    v_mfma_f32_32x32x16_bf16 v[32:47], v[64:67], v[140:143], v[32:47]
    buffer_load_dwordx4 v[104:107], v2, s[36:39], s80 offen offset:1024 sc1
    ds_read_b64_tr_b16 v[20:21], v236 offset:16384
    ds_read_b64_tr_b16 v[22:23], v236 offset:17408
    v_sub_f32 v190, v174, v232
    s_waitcnt vmcnt(9) lgkmcnt(12)
    v_mfma_f32_32x32x16_bf16 v[48:63], v[76:79], v[240:243], v[48:63]
    ds_read_b64_tr_b16 v[68:69], v237 offset:20480
    ds_read_b64_tr_b16 v[70:71], v237 offset:21504
    v_sub_f32 v191, v175, v232
    v_mul_f32 v176, v176, v233
    v_mfma_f32_32x32x16_bf16 v[32:47], v[72:75], v[240:243], v[32:47]
    buffer_load_dwordx4 v[108:111], v2, s[36:39], s80 offen offset:2048 sc1
    ds_read_b64_tr_b16 v[64:65], v236 offset:20480
    ds_read_b64_tr_b16 v[66:67], v236 offset:21504
    v_mul_f32 v177, v177, v233
    s_waitcnt vmcnt(9) lgkmcnt(12)
    v_mfma_f32_32x32x16_bf16 v[48:63], v[148:151], v[244:247], v[48:63]
    ds_read_b64_tr_b16 v[76:77], v237 offset:24576
    ds_read_b64_tr_b16 v[78:79], v237 offset:25600
    v_mul_f32 v178, v178, v233
    v_mul_f32 v179, v179, v233
    v_mfma_f32_32x32x16_bf16 v[32:47], v[144:147], v[244:247], v[32:47]
    buffer_load_dwordx4 v[112:115], v2, s[36:39], s80 offen offset:3072 sc1
    ds_read_b64_tr_b16 v[72:73], v236 offset:24576
    ds_read_b64_tr_b16 v[74:75], v236 offset:25600
    v_mul_f32 v180, v180, v233
    s_waitcnt vmcnt(9) lgkmcnt(12)
    v_mfma_f32_32x32x16_bf16 v[48:63], v[16:19], v[248:251], v[48:63]
    ds_read_b64_tr_b16 v[148:149], v237 offset:28672
    ds_read_b64_tr_b16 v[150:151], v237 offset:29696
    v_mul_f32 v181, v181, v233
    v_mul_f32 v182, v182, v233
    v_mfma_f32_32x32x16_bf16 v[32:47], v[12:15], v[248:251], v[32:47]
    s_add_u32 s80, s59, 28672
    buffer_load_dwordx4 v[116:119], v2, s[36:39], s80 offen offset:0 sc1
    ds_read_b64_tr_b16 v[144:145], v236 offset:28672
    ds_read_b64_tr_b16 v[146:147], v236 offset:29696
    s_waitcnt vmcnt(9) lgkmcnt(12)
    v_mfma_f32_32x32x16_bf16 v[48:63], v[24:27], v[80:83], v[48:63]
    ds_read_b64_tr_b16 v[16:17], v237 offset:32768
    ds_read_b64_tr_b16 v[18:19], v237 offset:33792
    v_mul_f32 v183, v183, v233
    v_mul_f32 v184, v184, v233
    v_mfma_f32_32x32x16_bf16 v[32:47], v[20:23], v[80:83], v[32:47]
    buffer_load_dwordx4 v[120:123], v2, s[36:39], s80 offen offset:1024 sc1
    ds_read_b64_tr_b16 v[12:13], v236 offset:32768
    ds_read_b64_tr_b16 v[14:15], v236 offset:33792
    v_mov_b32 v255, 8
    s_mov_b64 exec, 1
    ds_write_b32 v30, v255
    s_mov_b64 exec, -1
    s_waitcnt vmcnt(9) lgkmcnt(13)
    v_mfma_f32_32x32x16_bf16 v[48:63], v[68:71], v[84:87], v[48:63]
    ds_read_b64_tr_b16 v[24:25], v237 offset:36864
    ds_read_b64_tr_b16 v[26:27], v237 offset:37888
    buffer_load_dwordx4 v[124:127], v2, s[36:39], s80 offen offset:2048 sc1
    v_mul_f32 v185, v185, v233
    v_mfma_f32_32x32x16_bf16 v[32:47], v[64:67], v[84:87], v[32:47]
    ds_read_b64_tr_b16 v[20:21], v236 offset:36864
    ds_read_b64_tr_b16 v[22:23], v236 offset:37888
    v_mul_f32 v186, v186, v233
    v_mul_f32 v187, v187, v233
    s_waitcnt vmcnt(9) lgkmcnt(13)
    v_mfma_f32_32x32x16_bf16 v[48:63], v[76:79], v[88:91], v[48:63]
    buffer_load_dwordx4 v[128:131], v2, s[36:39], s80 offen offset:3072 sc1
    ds_read_b64_tr_b16 v[68:69], v237 offset:40960
    ds_read_b64_tr_b16 v[70:71], v237 offset:41984
    v_mul_f32 v188, v188, v233
    v_mfma_f32_32x32x16_bf16 v[32:47], v[72:75], v[88:91], v[32:47]
    ds_read_b64_tr_b16 v[64:65], v236 offset:40960
    ds_read_b64_tr_b16 v[66:67], v236 offset:41984
    v_mul_f32 v189, v189, v233
    v_mul_f32 v190, v190, v233
    s_waitcnt vmcnt(9) lgkmcnt(13)
    s_add_u32 s80, s59, 32768
    buffer_load_dwordx4 v[132:135], v2, s[36:39], s80 offen offset:0 sc1
    v_mfma_f32_32x32x16_bf16 v[48:63], v[148:151], v[92:95], v[48:63]
    ds_read_b64_tr_b16 v[76:77], v237 offset:45056
    ds_read_b64_tr_b16 v[78:79], v237 offset:46080
    v_mul_f32 v191, v191, v233
    v_mfma_f32_32x32x16_bf16 v[32:47], v[144:147], v[92:95], v[32:47]
    ds_read_b64_tr_b16 v[72:73], v236 offset:45056
    ds_read_b64_tr_b16 v[74:75], v236 offset:46080
    buffer_load_dwordx4 v[136:139], v2, s[36:39], s80 offen offset:1024 sc1
    ds_read_b128 v[4:7], v29 offset:0
    s_waitcnt vmcnt(10) lgkmcnt(14)
    v_mfma_f32_32x32x16_bf16 v[48:63], v[16:19], v[96:99], v[48:63]
    ds_read_b64_tr_b16 v[148:149], v237 offset:49152
    ds_read_b64_tr_b16 v[150:151], v237 offset:50176
    v_mfma_f32_32x32x16_bf16 v[32:47], v[12:15], v[96:99], v[32:47]
    buffer_load_dwordx4 v[140:143], v2, s[36:39], s80 offen offset:2048 sc1
    ds_read_b64_tr_b16 v[144:145], v236 offset:49152
    ds_read_b64_tr_b16 v[146:147], v236 offset:50176
    s_waitcnt lgkmcnt(4)
C20:
    v_min3_u32 v4, v4, v5, v6
    v_min_u32 v4, v4, v7
    v_cmp_gt_u32 vcc, 8, v4
    s_cbranch_vccz C21
    ds_read_b128 v[4:7], v29 offset:0
    s_waitcnt lgkmcnt(0)
    s_branch C20
C21:
    s_waitcnt vmcnt(10)
    v_mfma_f32_32x32x16_bf16 v[48:63], v[24:27], v[100:103], v[48:63]
    ds_read_b64_tr_b16 v[16:17], v237 offset:53248
    buffer_load_dwordx4 v[240:243], v2, s[36:39], s80 offen offset:3072 sc1
    ds_read_b64_tr_b16 v[18:19], v237 offset:54272
    v_mfma_f32_32x32x16_bf16 v[32:47], v[20:23], v[100:103], v[32:47]
    ds_read_b64_tr_b16 v[12:13], v236 offset:53248
    ds_read_b64_tr_b16 v[14:15], v236 offset:54272
    s_waitcnt vmcnt(10)
    v_mfma_f32_32x32x16_bf16 v[48:63], v[68:71], v[104:107], v[48:63]
    s_add_u32 s80, s59, 36864
    buffer_load_dwordx4 v[244:247], v2, s[36:39], s80 offen offset:0 sc1
    ds_read_b64_tr_b16 v[24:25], v237 offset:57344
    ds_read_b64_tr_b16 v[26:27], v237 offset:58368
    v_mfma_f32_32x32x16_bf16 v[32:47], v[64:67], v[104:107], v[32:47]
    ds_read_b64_tr_b16 v[20:21], v236 offset:57344
    ds_read_b64_tr_b16 v[22:23], v236 offset:58368
    s_waitcnt vmcnt(10)
    v_mfma_f32_32x32x16_bf16 v[48:63], v[76:79], v[108:111], v[48:63]
    buffer_load_dwordx4 v[248:251], v2, s[36:39], s80 offen offset:1024 sc1
    ds_read_b64_tr_b16 v[68:69], v239 offset:0
    ds_read_b64_tr_b16 v[70:71], v239 offset:1024
    v_mfma_f32_32x32x16_bf16 v[32:47], v[72:75], v[108:111], v[32:47]
    ds_read_b64_tr_b16 v[64:65], v238 offset:0
    ds_read_b64_tr_b16 v[66:67], v238 offset:1024
    ds_read_b128 v[4:7], v29 offset:16
    s_waitcnt vmcnt(10) lgkmcnt(13)
    v_mfma_f32_32x32x16_bf16 v[48:63], v[148:151], v[112:115], v[48:63]
    buffer_load_dwordx4 v[80:83], v2, s[36:39], s80 offen offset:2048 sc1
    ds_read_b64_tr_b16 v[76:77], v239 offset:4096
    ds_read_b64_tr_b16 v[78:79], v239 offset:5120
    v_mfma_f32_32x32x16_bf16 v[32:47], v[144:147], v[112:115], v[32:47]
    ds_read_b64_tr_b16 v[72:73], v238 offset:4096
    ds_read_b64_tr_b16 v[74:75], v238 offset:5120
    s_waitcnt lgkmcnt(4)
C22:
    v_min3_u32 v4, v4, v5, v6
    v_min_u32 v4, v4, v7
    v_cmp_gt_u32 vcc, 8, v4
    s_cbranch_vccz C23
    ds_read_b128 v[4:7], v29 offset:16
    s_waitcnt lgkmcnt(0)
    s_branch C22
C23:
    buffer_load_dwordx4 v[84:87], v2, s[36:39], s80 offen offset:3072 sc1
    s_waitcnt vmcnt(11)
    v_mfma_f32_32x32x16_bf16 v[48:63], v[16:19], v[116:119], v[48:63]
    ds_read_b64_tr_b16 v[148:149], v239 offset:8192
    ds_read_b64_tr_b16 v[150:151], v239 offset:9216
    v_mfma_f32_32x32x16_bf16 v[32:47], v[12:15], v[116:119], v[32:47]
    ds_read_b64_tr_b16 v[144:145], v238 offset:8192
    s_add_u32 s80, s59, 40960
    buffer_load_dwordx4 v[88:91], v2, s[36:39], s80 offen offset:0 sc1
    ds_read_b64_tr_b16 v[146:147], v238 offset:9216
    s_waitcnt vmcnt(11)
    v_mfma_f32_32x32x16_bf16 v[48:63], v[24:27], v[120:123], v[48:63]
    ds_read_b64_tr_b16 v[16:17], v239 offset:12288
    ds_read_b64_tr_b16 v[18:19], v239 offset:13312
    v_mfma_f32_32x32x16_bf16 v[32:47], v[20:23], v[120:123], v[32:47]
    buffer_load_dwordx4 v[92:95], v2, s[36:39], s80 offen offset:1024 sc1
    ds_read_b64_tr_b16 v[12:13], v238 offset:12288
    ds_read_b64_tr_b16 v[14:15], v238 offset:13312
    s_waitcnt vmcnt(11)
    v_mfma_f32_32x32x16_bf16 v[48:63], v[68:71], v[124:127], v[48:63]
    ds_read_b64_tr_b16 v[24:25], v239 offset:16384
    ds_read_b64_tr_b16 v[26:27], v239 offset:17408
    v_mfma_f32_32x32x16_bf16 v[32:47], v[64:67], v[124:127], v[32:47]
    buffer_load_dwordx4 v[96:99], v2, s[36:39], s80 offen offset:2048 sc1
    ds_read_b64_tr_b16 v[20:21], v238 offset:16384
    ds_read_b64_tr_b16 v[22:23], v238 offset:17408
    ds_read_b128 v[4:7], v29 offset:0
    s_waitcnt vmcnt(11) lgkmcnt(13)
    v_mfma_f32_32x32x16_bf16 v[48:63], v[76:79], v[128:131], v[48:63]
    ds_read_b64_tr_b16 v[68:69], v239 offset:20480
    ds_read_b64_tr_b16 v[70:71], v239 offset:21504
    v_mfma_f32_32x32x16_bf16 v[32:47], v[72:75], v[128:131], v[32:47]
    ds_read_b64_tr_b16 v[64:65], v238 offset:20480
    ds_read_b64_tr_b16 v[66:67], v238 offset:21504
    s_waitcnt lgkmcnt(4)
C24:
    v_min3_u32 v4, v4, v5, v6
    v_min_u32 v4, v4, v7
    v_cmp_gt_u32 vcc, 9, v4
    s_cbranch_vccz C25
    ds_read_b128 v[4:7], v29 offset:0
    s_waitcnt lgkmcnt(0)
    s_branch C24
C25:
    s_waitcnt vmcnt(10)
    v_mfma_f32_32x32x16_bf16 v[48:63], v[148:151], v[132:135], v[48:63]
    ds_read_b64_tr_b16 v[76:77], v235 offset:0
    ds_read_b64_tr_b16 v[78:79], v235 offset:1024
    v_mfma_f32_32x32x16_bf16 v[32:47], v[144:147], v[132:135], v[32:47]
    ds_read_b64_tr_b16 v[72:73], v234 offset:0
    ds_read_b64_tr_b16 v[74:75], v234 offset:1024
    s_waitcnt vmcnt(9)
    v_mfma_f32_32x32x16_bf16 v[48:63], v[16:19], v[136:139], v[48:63]
    ds_read_b64_tr_b16 v[148:149], v235 offset:4096
    ds_read_b64_tr_b16 v[150:151], v235 offset:5120
    v_mfma_f32_32x32x16_bf16 v[32:47], v[12:15], v[136:139], v[32:47]
    ds_read_b64_tr_b16 v[144:145], v234 offset:4096
    ds_read_b64_tr_b16 v[146:147], v234 offset:5120
    s_waitcnt vmcnt(8)
    v_mfma_f32_32x32x16_bf16 v[48:63], v[24:27], v[140:143], v[48:63]
    ds_read_b64_tr_b16 v[16:17], v235 offset:8192
    ds_read_b64_tr_b16 v[18:19], v235 offset:9216
    v_mfma_f32_32x32x16_bf16 v[32:47], v[20:23], v[140:143], v[32:47]
    ds_read_b64_tr_b16 v[12:13], v234 offset:8192
    ds_read_b64_tr_b16 v[14:15], v234 offset:9216
    s_waitcnt vmcnt(7) lgkmcnt(12)
    v_mfma_f32_32x32x16_bf16 v[48:63], v[68:71], v[240:243], v[48:63]
    ds_read_b64_tr_b16 v[24:25], v235 offset:12288
    ds_read_b64_tr_b16 v[26:27], v235 offset:13312
    v_mfma_f32_32x32x16_bf16 v[32:47], v[64:67], v[240:243], v[32:47]
    ds_read_b64_tr_b16 v[20:21], v234 offset:12288
    ds_read_b64_tr_b16 v[22:23], v234 offset:13312
    ds_read_b128 v[4:7], v29 offset:0
    s_waitcnt vmcnt(6) lgkmcnt(13)
    v_mfma_f32_32x32x16_bf16 v[48:63], v[76:79], v[244:247], v[48:63]
    ds_read_b64_tr_b16 v[68:69], v235 offset:16384
    ds_read_b64_tr_b16 v[70:71], v235 offset:17408
    v_mfma_f32_32x32x16_bf16 v[32:47], v[72:75], v[244:247], v[32:47]
    ds_read_b64_tr_b16 v[64:65], v234 offset:16384
    ds_read_b64_tr_b16 v[66:67], v234 offset:17408
    s_waitcnt lgkmcnt(4)
C26:
    v_min3_u32 v4, v4, v5, v6
    v_min_u32 v4, v4, v7
    v_cmp_gt_u32 vcc, 10, v4
    s_cbranch_vccz C27
    ds_read_b128 v[4:7], v29 offset:0
    s_waitcnt lgkmcnt(0)
    s_branch C26
C27:
    s_waitcnt vmcnt(5)
    v_mfma_f32_32x32x16_bf16 v[48:63], v[148:151], v[248:251], v[48:63]
    ds_read_b64_tr_b16 v[76:77], v235 offset:20480
    ds_read_b64_tr_b16 v[78:79], v235 offset:21504
    ds_read_b64_tr_b16 v[72:73], v234 offset:20480
    ds_read_b64_tr_b16 v[74:75], v234 offset:21504
    ds_read_b32 v208, v9 offset:0
    ds_read_b32 v209, v9 offset:256
    v_mfma_f32_32x32x16_bf16 v[32:47], v[144:147], v[248:251], v[32:47]
    ds_read_b32 v210, v9 offset:512
    ds_read_b32 v211, v9 offset:768
    ds_read_b32 v212, v9 offset:2048
    ds_read_b32 v213, v9 offset:2304
    ds_read_b32 v214, v9 offset:2560
    ds_read_b32 v215, v9 offset:2816
    s_waitcnt vmcnt(4)
    v_mfma_f32_32x32x16_bf16 v[48:63], v[16:19], v[80:83], v[48:63]
    ds_read_b64_tr_b16 v[148:149], v235 offset:24576
    ds_read_b64_tr_b16 v[150:151], v235 offset:25600
    v_mfma_f32_32x32x16_bf16 v[32:47], v[12:15], v[80:83], v[32:47]
    ds_read_b64_tr_b16 v[144:145], v234 offset:24576
    ds_read_b64_tr_b16 v[146:147], v234 offset:25600
    s_waitcnt lgkmcnt(11)
    v_lshlrev_b32 v192, 16, v208
    s_waitcnt vmcnt(3)
    v_mfma_f32_32x32x16_bf16 v[48:63], v[24:27], v[84:87], v[48:63]
    v_and_b32 v193, s73, v208
    s_waitcnt lgkmcnt(10)
    v_lshlrev_b32 v194, 16, v209
    v_and_b32 v195, s73, v209
    s_waitcnt vmcnt(2)
    v_mfma_f32_32x32x16_bf16 v[48:63], v[68:71], v[88:91], v[48:63]
    s_waitcnt lgkmcnt(9)
    v_lshlrev_b32 v196, 16, v210
    v_and_b32 v197, s73, v210
    s_waitcnt lgkmcnt(8)
    v_lshlrev_b32 v198, 16, v211
    s_waitcnt vmcnt(1)
    v_mfma_f32_32x32x16_bf16 v[48:63], v[76:79], v[92:95], v[48:63]
    v_and_b32 v199, s73, v211
    s_waitcnt lgkmcnt(7)
    v_lshlrev_b32 v200, 16, v212
    v_and_b32 v201, s73, v212
    s_waitcnt vmcnt(0) lgkmcnt(0)
    v_mfma_f32_32x32x16_bf16 v[48:63], v[148:151], v[96:99], v[48:63]
    v_lshlrev_b32 v202, 16, v213
    v_and_b32 v203, s73, v213
    v_lshlrev_b32 v204, 16, v214
    v_and_b32 v205, s73, v214
    v_mfma_f32_32x32x16_bf16 v[32:47], v[20:23], v[84:87], v[32:47]
    v_lshlrev_b32 v206, 16, v215
    v_and_b32 v207, s73, v215
    v_fmac_f32 v160, v176, v192
    v_fmac_f32 v161, v177, v193
    v_mfma_f32_32x32x16_bf16 v[32:47], v[64:67], v[88:91], v[32:47]
    s_nop 1
    ds_write_b128 v222, v[48:51] offset:0
    v_mfma_f32_32x32x16_bf16 v[32:47], v[72:75], v[92:95], v[32:47]
    ds_write_b128 v222, v[52:55] offset:1024
    v_mfma_f32_32x32x16_bf16 v[32:47], v[144:147], v[96:99], v[32:47]
    ds_write_b128 v222, v[56:59] offset:2048
    ds_write_b128 v222, v[60:63] offset:3072
    v_fmac_f32 v162, v178, v194
    v_fmac_f32 v163, v179, v195
    v_fmac_f32 v164, v180, v196
    v_fmac_f32 v165, v181, v197
    v_fmac_f32 v166, v182, v198
    v_fmac_f32 v167, v183, v199
    v_fmac_f32 v168, v184, v200
    v_fmac_f32 v169, v185, v201
    v_fmac_f32 v170, v186, v202
    v_fmac_f32 v171, v187, v203
    v_fmac_f32 v172, v188, v204
    v_fmac_f32 v173, v189, v205
    v_fmac_f32 v174, v190, v206
    v_fmac_f32 v175, v191, v207
    v_pk_add_f32 v[160:161], v[160:161], v[32:33]
    v_pk_add_f32 v[162:163], v[162:163], v[34:35]
    v_pk_add_f32 v[164:165], v[164:165], v[36:37]
    v_pk_add_f32 v[166:167], v[166:167], v[38:39]
    v_pk_add_f32 v[168:169], v[168:169], v[40:41]
    v_pk_add_f32 v[170:171], v[170:171], v[42:43]
    v_pk_add_f32 v[172:173], v[172:173], v[44:45]
    v_pk_add_f32 v[174:175], v[174:175], v[46:47]
    s_waitcnt lgkmcnt(0)
    s_barrier
    ds_read_b128 v[64:67], v223 offset:0
    ds_read_b128 v[68:71], v223 offset:1024
    ds_read_b128 v[72:75], v223 offset:2048
    ds_read_b128 v[76:79], v223 offset:3072
    s_waitcnt lgkmcnt(3)
    v_pk_add_f32 v[160:161], v[160:161], v[64:65]
    v_pk_add_f32 v[162:163], v[162:163], v[66:67]
    s_waitcnt lgkmcnt(2)
    v_pk_add_f32 v[164:165], v[164:165], v[68:69]
    v_pk_add_f32 v[166:167], v[166:167], v[70:71]
    v_cvt_pk_bf16_f32 v96, v160, v161
    v_cvt_pk_bf16_f32 v97, v162, v163
    v_cvt_pk_bf16_f32 v98, v164, v165
    v_cvt_pk_bf16_f32 v99, v166, v167
    ds_write_b128 v227, v[96:99]
    s_waitcnt lgkmcnt(2)
    v_pk_add_f32 v[168:169], v[168:169], v[72:73]
    v_pk_add_f32 v[170:171], v[170:171], v[74:75]
    s_waitcnt lgkmcnt(1)
    v_pk_add_f32 v[172:173], v[172:173], v[76:77]
    v_pk_add_f32 v[174:175], v[174:175], v[78:79]
    v_cvt_pk_bf16_f32 v100, v168, v169
    v_cvt_pk_bf16_f32 v101, v170, v171
    v_cvt_pk_bf16_f32 v102, v172, v173
    v_cvt_pk_bf16_f32 v103, v174, v175
    ds_write_b128 v228, v[100:103]
    s_waitcnt lgkmcnt(0)
    ds_read_b128 v[104:107], v229
    ds_read_b128 v[108:111], v229 offset:1024
    s_waitcnt lgkmcnt(1)
    buffer_store_dwordx4 v[104:107], v230, s[32:35], s92 offen sc1
    s_waitcnt lgkmcnt(0)
    buffer_store_dwordx4 v[108:111], v230, s[32:35], s93 offen sc1
    s_endpgm
L_loader2:
    s_mul_i32 s60, s72, 8448
    s_mul_i32 s61, s71, 4228
    s_add_u32 s61, s61, s60
    s_add_u32 s76, s61, 133184
    s_lshl_b32 s77, s48, 13
    s_add_u32 s88, s77, 1048576
    s_lshl_b32 s61, s72, 12
    s_add_u32 s77, s77, s61
    s_waitcnt lgkmcnt(0)
    s_add_u32 s51, s43, 1
    s_not_b32 s52, s51
    v_mov_b32 v255, 0
    s_mov_b64 exec, 1
    ds_write_b32 v30, v255
    s_mov_b64 exec, -1
    v_and_b32 v35, 1, v32
    v_lshlrev_b32 v35, 2, v35
    v_xor_b32 v35, v35, v34
    v_lshl_add_u32 v16, v35, 4, v33
    s_mul_i32 s58, s72, 704512
    s_lshl_b32 s61, s71, 13
    s_add_u32 s58, s58, s61
    s_lshl_b32 s61, s47, 7
    s_add_u32 s58, s58, s61
    v_add_u32 v17, s62, v2
    v_add_u32 v11, 61440, v17
    v_add_u32 v3, 122880, v17
    s_lshl_b32 s60, s46, 1
    s_add_u32 s60, s60, s71
    s_mul_i32 s60, s60, 86
    s_mul_i32 s61, s72, 43
    s_add_u32 s60, s60, s61
    s_lshl_b32 s60, s60, 10
    s_add_u32 s59, s60, 5242880
    s_mul_i32 s60, s72, 7
    v_min_u32 v38, 8, v1
    v_add_u32 v35, s60, v38
    v_lshrrev_b32 v36, 1, v35
    v_xor_b32 v36, 4, v36
    v_lshlrev_b32 v36, 12, v36
    v_and_b32 v35, 1, v35
    v_lshl_add_u32 v37, v35, 7, v36
    s_lshl_b32 s60, s44, 8
    s_add_u32 s60, s60, 655360
    s_and_b32 s61, s46, 1
    s_lshl_b32 s61, s61, 1
    s_add_u32 s61, s61, s71
    s_lshl_b32 s61, s61, 15
    s_add_u32 s61, s61, s60
    v_add_u32 v18, s61, v37
    s_lshl_b32 s60, s47, 12
    s_and_b32 s61, s46, 24
    s_lshl_b32 s61, s61, 12
    s_add_u32 s60, s60, s61
    s_add_u32 s60, s60, 524288
    s_lshl_b32 s61, s49, 3
    v_add_u32 v35, s61, v38
    v_max_u32 v35, 1, v35
    v_subrev_u32 v35, 1, v35
    v_lshlrev_b32 v35, 7, v35
    v_add_u32 v22, s60, v35
    s_add_u32 s60, s60, s62
    s_add_u32 s60, s60, 262144
    v_lshlrev_b32 v35, 7, v34
    v_add_u32 v19, s60, v35
    s_lshl_b32 s60, s46, 16
    s_lshl_b32 s61, s47, 13
    s_add_u32 s60, s60, s61
    s_add_u32 s60, s60, s74
    s_add_u32 s91, s60, 3145728
    v_lshlrev_b32 v23, 5, v0
    v_subrev_u32 v24, 4, v23
    v_add_u32 v25, 115136, v17
    s_mul_i32 s60, s72, 9216
    s_mul_i32 s61, s71, 4640
    s_add_u32 s61, s61, s60
    s_add_u32 s61, s61, 114688
    v_min_u32 v35, 27, v1
    v_lshlrev_b32 v35, 4, v35
    v_add_u32 v26, s61, v35
    s_sub_u32 s61, s76, 64
    v_and_b32 v35, 15, v1
    v_lshlrev_b32 v35, 2, v35
    v_add_u32 v27, s61, v35
    s_mov_b32 s65, 0x05040100
    s_mov_b32 s66, 0x07060302
    s_mov_b32 s73, 0xffff0000
    s_lshl_b32 s78, s42, 16
    s_and_b32 s79, s42, s73
    v_and_b32 v36, 15, v1
    v_bfe_u32 v35, v1, 2, 2
    v_lshlrev_b32 v35, 4, v35
    v_lshl_add_u32 v35, v32, 7, v35
    v_and_b32 v37, 3, v1
    v_xor_b32 v37, 3, v37
    v_lshl_add_u32 v35, v37, 2, v35
    s_add_u32 s60, s62, 119776
    v_add_u32 v248, s60, v35
    s_add_u32 s60, s74, 114688
    v_add_u32 v246, s60, v2
    v_lshlrev_b32 v247, 16, v32
    v_lshl_add_u32 v247, v36, 4, v247
    s_lshl_b32 s60, s49, 19
    s_lshl_b32 s61, s48, 8
    s_add_u32 s60, s60, s61
    s_add_u32 s89, s60, 3145728
    s_add_u32 s90, s89, 0x40000
    s_lshl_b32 s60, s48, 7
    s_lshl_b32 s61, s49, 15
    s_add_u32 s60, s60, s61
    s_add_u32 s60, s60, 524288
    v_lshlrev_b32 v28, 3, v36
    v_add_u32 v28, s60, v28
    v_mul_u32_u24 v128, 5, v34
    v_add_u32 v128, s51, v128
    v_lshrrev_b32 v129, 1, v128
    v_lshrrev_b32 v130, 2, v128
    v_lshrrev_b32 v131, 3, v128
    v_mov_b32 v60, 0
    v_mov_b32 v61, 0
    v_mov_b32 v62, 0
    v_mov_b32 v63, 0
    s_waitcnt vmcnt(4) lgkmcnt(0)
    s_barrier
    s_add_u32 m0, s63, 1024
    s_nop 0
    buffer_load_dwordx4 v5, s[4:7], s80 offen lds
    s_add_u32 m0, s63, 2048
    s_nop 0
    buffer_load_dwordx4 v6, s[4:7], s80 offen lds
    s_add_u32 m0, s63, 3072
    s_nop 0
    buffer_load_dwordx4 v7, s[4:7], s80 offen lds
    s_add_u32 s95, s94, 1
    s_and_b32 s95, s95, 7
    s_mul_i32 s81, s95, 176128
    s_add_u32 s81, s81, s55
    s_lshl_b32 s80, s95, 7
    s_add_u32 s80, s80, s54
    s_add_u32 m0, s64, 45056
    s_nop 0
    buffer_load_dwordx4 v8, s[24:27], s81 offen lds
    s_add_u32 m0, s64, 46080
    s_nop 0
    buffer_load_dwordx4 v9, s[24:27], s81 offen lds
    s_add_u32 m0, s64, 47104
    s_nop 0
    buffer_load_dwordx4 v10, s[24:27], s81 offen lds
    s_add_u32 m0, s63, 28672
    s_nop 0
    buffer_load_dwordx4 v4, s[4:7], s80 offen lds
    s_add_u32 m0, s63, 29696
    s_nop 0
    buffer_load_dwordx4 v5, s[4:7], s80 offen lds
    s_add_u32 m0, s63, 30720
    s_nop 0
    buffer_load_dwordx4 v6, s[4:7], s80 offen lds
    s_add_u32 m0, s63, 31744
    s_nop 0
    buffer_load_dwordx4 v7, s[4:7], s80 offen lds
    s_waitcnt vmcnt(7)
    s_barrier
    s_add_u32 s95, s94, 2
    s_and_b32 s95, s95, 7
    s_mul_i32 s81, s95, 176128
    s_add_u32 s81, s81, s55
    s_lshl_b32 s80, s95, 7
    s_add_u32 s80, s80, s54
    s_add_u32 m0, s64, 73728
    s_nop 0
    buffer_load_dwordx4 v8, s[24:27], s81 offen lds
    s_add_u32 m0, s64, 74752
    s_nop 0
    buffer_load_dwordx4 v9, s[24:27], s81 offen lds
    s_add_u32 m0, s64, 75776
    s_nop 0
    buffer_load_dwordx4 v10, s[24:27], s81 offen lds
    s_add_u32 m0, s63, 57344
    s_nop 0
    buffer_load_dwordx4 v4, s[4:7], s80 offen lds
    s_add_u32 m0, s63, 58368
    s_nop 0
    buffer_load_dwordx4 v5, s[4:7], s80 offen lds
    s_add_u32 m0, s63, 59392
    s_nop 0
    buffer_load_dwordx4 v6, s[4:7], s80 offen lds
    s_add_u32 m0, s63, 60416
    s_nop 0
    buffer_load_dwordx4 v7, s[4:7], s80 offen lds
    s_add_u32 s95, s94, 3
    s_and_b32 s95, s95, 7
    s_mul_i32 s81, s95, 176128
    s_add_u32 s81, s81, s55
    s_lshl_b32 s80, s95, 7
    s_add_u32 s80, s80, s54
    s_add_u32 m0, s64, 102400
    s_nop 0
    buffer_load_dwordx4 v8, s[24:27], s81 offen lds
    s_add_u32 m0, s64, 103424
    s_nop 0
    buffer_load_dwordx4 v9, s[24:27], s81 offen lds
    s_add_u32 m0, s64, 104448
    s_nop 0
    buffer_load_dwordx4 v10, s[24:27], s81 offen lds
    s_waitcnt vmcnt(10)
    s_barrier
    s_add_u32 m0, s63, 86016
    s_nop 0
    buffer_load_dwordx4 v4, s[4:7], s80 offen lds
    s_add_u32 m0, s63, 87040
    s_nop 0
    buffer_load_dwordx4 v5, s[4:7], s80 offen lds
    s_add_u32 m0, s63, 88064
    s_nop 0
    buffer_load_dwordx4 v6, s[4:7], s80 offen lds
    s_add_u32 m0, s63, 89088
    s_nop 0
    buffer_load_dwordx4 v7, s[4:7], s80 offen lds
    s_add_u32 s95, s94, 4
    s_and_b32 s95, s95, 7
    s_mul_i32 s81, s95, 176128
    s_add_u32 s81, s81, s55
    s_lshl_b32 s80, s95, 7
    s_add_u32 s80, s80, s54
    s_add_u32 m0, s64, 16384
    s_nop 0
    buffer_load_dwordx4 v8, s[24:27], s81 offen lds
    s_add_u32 m0, s64, 17408
    s_nop 0
    buffer_load_dwordx4 v9, s[24:27], s81 offen lds
    s_add_u32 m0, s64, 18432
    s_nop 0
    buffer_load_dwordx4 v10, s[24:27], s81 offen lds
    s_waitcnt vmcnt(10)
    s_barrier
    s_add_u32 m0, s63, 0
    s_nop 0
    buffer_load_dwordx4 v4, s[4:7], s80 offen lds
    s_add_u32 m0, s63, 1024
    s_nop 0
    buffer_load_dwordx4 v5, s[4:7], s80 offen lds
    s_add_u32 m0, s63, 2048
    s_nop 0
    buffer_load_dwordx4 v6, s[4:7], s80 offen lds
    s_add_u32 m0, s63, 3072
    s_nop 0
    buffer_load_dwordx4 v7, s[4:7], s80 offen lds
    s_add_u32 s95, s94, 5
    s_and_b32 s95, s95, 7
    s_mul_i32 s81, s95, 176128
    s_add_u32 s81, s81, s55
    s_lshl_b32 s80, s95, 7
    s_add_u32 s80, s80, s54
    s_add_u32 m0, s64, 45056
    s_nop 0
    buffer_load_dwordx4 v8, s[24:27], s81 offen lds
    s_add_u32 m0, s64, 46080
    s_nop 0
    buffer_load_dwordx4 v9, s[24:27], s81 offen lds
    s_add_u32 m0, s64, 47104
    s_nop 0
    buffer_load_dwordx4 v10, s[24:27], s81 offen lds
    s_waitcnt vmcnt(10)
    s_barrier
    s_add_u32 m0, s63, 28672
    s_nop 0
    buffer_load_dwordx4 v4, s[4:7], s80 offen lds
    s_add_u32 m0, s63, 29696
    s_nop 0
    buffer_load_dwordx4 v5, s[4:7], s80 offen lds
    s_add_u32 m0, s63, 30720
    s_nop 0
    buffer_load_dwordx4 v6, s[4:7], s80 offen lds
    s_add_u32 m0, s63, 31744
    s_nop 0
    buffer_load_dwordx4 v7, s[4:7], s80 offen lds
    s_add_u32 s95, s94, 6
    s_and_b32 s95, s95, 7
    s_mul_i32 s81, s95, 176128
    s_add_u32 s81, s81, s55
    s_lshl_b32 s80, s95, 7
    s_add_u32 s80, s80, s54
    s_add_u32 m0, s64, 73728
    s_nop 0
    buffer_load_dwordx4 v8, s[24:27], s81 offen lds
    s_add_u32 m0, s64, 74752
    s_nop 0
    buffer_load_dwordx4 v9, s[24:27], s81 offen lds
    s_add_u32 m0, s64, 75776
    s_nop 0
    buffer_load_dwordx4 v10, s[24:27], s81 offen lds
    s_waitcnt vmcnt(10)
    s_barrier
    s_waitcnt vmcnt(9)
    s_add_u32 m0, s63, 57344
    s_nop 0
    buffer_load_dwordx4 v4, s[4:7], s80 offen lds
    s_waitcnt vmcnt(9)
    s_add_u32 m0, s63, 58368
    s_nop 0
    buffer_load_dwordx4 v5, s[4:7], s80 offen lds
    s_waitcnt vmcnt(9)
    s_add_u32 m0, s63, 59392
    s_nop 0
    buffer_load_dwordx4 v6, s[4:7], s80 offen lds
    s_waitcnt vmcnt(9)
    s_add_u32 m0, s63, 60416
    s_nop 0
    buffer_load_dwordx4 v7, s[4:7], s80 offen lds
    s_waitcnt vmcnt(9)
    s_add_u32 s95, s94, 7
    s_and_b32 s95, s95, 7
    s_mul_i32 s81, s95, 176128
    s_add_u32 s81, s81, s55
    s_lshl_b32 s80, s95, 7
    s_add_u32 s80, s80, s54
    s_add_u32 m0, s64, 102400
    s_nop 0
    buffer_load_dwordx4 v8, s[24:27], s81 offen lds
    s_waitcnt vmcnt(9)
    s_add_u32 m0, s64, 103424
    s_nop 0
    buffer_load_dwordx4 v9, s[24:27], s81 offen lds
    s_waitcnt vmcnt(9)
    v_mov_b32 v255, 1
    s_mov_b64 exec, 1
    ds_write_b32 v30, v255
    s_mov_b64 exec, -1
    s_add_u32 m0, s64, 104448
    s_nop 0
    buffer_load_dwordx4 v10, s[24:27], s81 offen lds
    s_waitcnt vmcnt(9)
    s_add_u32 m0, s63, 86016
    s_nop 0
    buffer_load_dwordx4 v4, s[4:7], s80 offen lds
    s_waitcnt vmcnt(9)
    s_add_u32 m0, s63, 87040
    s_nop 0
    buffer_load_dwordx4 v5, s[4:7], s80 offen lds
    s_waitcnt vmcnt(9)
    s_add_u32 m0, s63, 88064
    s_nop 0
    buffer_load_dwordx4 v6, s[4:7], s80 offen lds
    s_waitcnt vmcnt(9)
    s_add_u32 m0, s63, 89088
    s_nop 0
    buffer_load_dwordx4 v7, s[4:7], s80 offen lds
    s_waitcnt vmcnt(9)
    s_add_u32 m0, s74, 150016
    s_nop 0
    buffer_load_dwordx4 v4, s[4:7], s101 offen lds
    s_waitcnt vmcnt(9)
    s_mov_b64 exec, 0x1ff
    buffer_load_dwordx2 v[20:21], v22, s[36:39], 0 offen sc1
    s_mov_b64 exec, -1
    s_waitcnt vmcnt(9)
    v_mov_b32 v255, 2
    s_mov_b64 exec, 1
    ds_write_b32 v30, v255
    s_mov_b64 exec, -1
    s_add_u32 m0, s74, 151040
    s_nop 0
    buffer_load_dwordx4 v5, s[4:7], s101 offen lds
    s_waitcnt vmcnt(9)
    s_cmp_lg_u32 s49, 2
    s_cbranch_scc1 L5
    s_mul_i32 s82, s2, 5504
    buffer_load_dword v254, v15, s[28:31], s82 offen
L5:
    s_cmp_lg_u32 s49, 3
    s_cbranch_scc1 L6
    s_mul_i32 s82, s75, 44032
    v_lshlrev_b32 v253, 3, v15
    buffer_load_dword v254, v253, s[28:31], s82 offen offset:384
L6:
    s_mov_b32 m0, s76
    s_nop 0
    buffer_load_dwordx4 v2, s[20:23], s77 offen offset:0 lds
    s_waitcnt vmcnt(9)
    s_mov_b32 m0, s76
    s_nop 0
    buffer_load_dwordx4 v2, s[20:23], s77 offen offset:1024 lds
    s_waitcnt vmcnt(9)
    s_mov_b32 m0, s76
    s_nop 0
    buffer_load_dwordx4 v2, s[20:23], s77 offen offset:2048 lds
    s_waitcnt vmcnt(9)
    s_mov_b32 m0, s76
    s_nop 0
    buffer_load_dwordx4 v2, s[20:23], s77 offen offset:3072 lds
    s_waitcnt vmcnt(9)
    s_add_u32 s92, s58, 458752
    buffer_load_dwordx4 v[176:179], v16, s[28:31], s92 offen
    s_waitcnt vmcnt(9)
    s_add_u32 s92, s58, 475136
    buffer_load_dwordx4 v[180:183], v16, s[28:31], s92 offen
    s_waitcnt vmcnt(9)
    v_mov_b32 v255, 3
    s_mov_b64 exec, 1
    ds_write_b32 v30, v255
    s_mov_b64 exec, -1
    s_add_u32 s92, s58, 491520
    buffer_load_dwordx4 v[184:187], v16, s[28:31], s92 offen
    s_waitcnt vmcnt(7)
    s_mov_b32 s70, 0
    s_mov_b64 exec, 0x1ff
L7:
    v_cmp_eq_u32 vcc, s51, v20
    v_cmp_eq_u32 s[68:69], s52, v21
    s_and_b64 vcc, vcc, s[68:69]
    s_cmp_eq_u64 vcc, exec
    s_cbranch_scc1 L8
    s_add_u32 s70, s70, 1
    s_cmp_gt_u32 s70, 131072
    s_cbranch_scc1 L8
    s_sleep 2
    buffer_load_dwordx2 v[20:21], v22, s[36:39], 0 offen sc1
    s_waitcnt vmcnt(0)
    s_branch L7
L8:
    s_mov_b64 exec, -1
    buffer_load_dwordx4 v[236:239], v23, s[36:39], s88 offen sc1
    buffer_load_dwordx4 v[240:243], v23, s[36:39], s88 offen offset:16 sc1
    buffer_load_dword v244, v24, s[36:39], s88 offen sc1
    s_waitcnt vmcnt(7)
    s_add_u32 s92, s58, 507904
    buffer_load_dwordx4 v[188:191], v16, s[28:31], s92 offen
    s_waitcnt vmcnt(7)
    s_add_u32 s92, s58, 524288
    buffer_load_dwordx4 v[192:195], v16, s[28:31], s92 offen
    s_waitcnt vmcnt(7)
    s_add_u32 s92, s58, 540672
    buffer_load_dwordx4 v[196:199], v16, s[28:31], s92 offen
    s_waitcnt vmcnt(7)
    s_add_u32 s92, s58, 557056
    buffer_load_dwordx4 v[200:203], v16, s[28:31], s92 offen
    s_waitcnt vmcnt(7)
    s_add_u32 s92, s58, 573440
    buffer_load_dwordx4 v[204:207], v16, s[28:31], s92 offen
    s_waitcnt vmcnt(7)
    s_add_u32 s92, s58, 589824
    buffer_load_dwordx4 v[208:211], v16, s[28:31], s92 offen
    s_waitcnt vmcnt(7)
    s_add_u32 s92, s58, 606208
    buffer_load_dwordx4 v[212:215], v16, s[28:31], s92 offen
    s_waitcnt vmcnt(7)
    s_add_u32 s92, s58, 622592
    buffer_load_dwordx4 v[216:219], v16, s[28:31], s92 offen
    s_waitcnt vmcnt(7)
    s_setprio 2
    ds_write_b128 v26, v[60:63]
    ds_write_b32 v27, v60
    v_perm_b32 v40, v241, v242, s65
    v_perm_b32 v41, v239, v240, s65
    v_perm_b32 v42, v237, v238, s65
    v_perm_b32 v43, v244, v236, s65
    ds_write_b128 v25, v[40:43] offset:0
    v_perm_b32 v44, v242, v243, s65
    v_perm_b32 v45, v240, v241, s65
    v_perm_b32 v46, v238, v239, s65
    v_perm_b32 v47, v236, v237, s65
    ds_write_b128 v25, v[44:47] offset:4640
    v_perm_b32 v48, v241, v242, s66
    v_perm_b32 v49, v239, v240, s66
    v_perm_b32 v50, v237, v238, s66
    v_perm_b32 v51, v244, v236, s66
    ds_write_b128 v25, v[48:51] offset:9216
    v_perm_b32 v52, v242, v243, s66
    v_perm_b32 v53, v240, v241, s66
    v_perm_b32 v54, v238, v239, s66
    v_perm_b32 v55, v236, v237, s66
    ds_write_b128 v25, v[52:55] offset:13856
    s_waitcnt lgkmcnt(0)
    ds_read_b32 v112, v248 offset:0
    ds_read_b32 v113, v248 offset:64
    ds_read_b32 v114, v248 offset:512
    ds_read_b32 v115, v248 offset:576
    ds_read_b32 v116, v248 offset:9216
    ds_read_b32 v117, v248 offset:9280
    ds_read_b32 v118, v248 offset:9728
    ds_read_b32 v119, v248 offset:9792
    v_mov_b32 v255, 4
    s_waitcnt lgkmcnt(0)
    s_mov_b64 exec, 1
    ds_write_b32 v30, v255
    s_mov_b64 exec, -1
    s_setprio 0
    s_add_u32 s92, s58, 638976
    buffer_load_dwordx4 v[220:223], v16, s[28:31], s92 offen
    s_waitcnt vmcnt(7)
    s_add_u32 s92, s58, 655360
    buffer_load_dwordx4 v[224:227], v16, s[28:31], s92 offen
    s_waitcnt vmcnt(7)
    s_add_u32 s92, s58, 671744
    buffer_load_dwordx4 v[228:231], v16, s[28:31], s92 offen
    s_waitcnt vmcnt(7)
    s_add_u32 s92, s58, 688128
    buffer_load_dwordx4 v[232:235], v16, s[28:31], s92 offen
    s_or_b32 s60, s48, s49
    s_cmp_lg_u32 s60, 0
    s_cbranch_scc1 L_noep
    v_add_u32 v40, 524288, v39
    v_add_u32 v41, 532480, v39
    v_add_u32 v42, 540672, v39
    v_add_u32 v43, 548864, v39
    s_mov_b32 s70, 0
L_ep:
    buffer_load_dwordx2 v[44:45], v40, s[36:39], 0 offen sc1
    buffer_load_dwordx2 v[46:47], v41, s[36:39], 0 offen sc1
    buffer_load_dwordx2 v[48:49], v42, s[36:39], 0 offen sc1
    buffer_load_dwordx2 v[50:51], v43, s[36:39], 0 offen sc1
    s_waitcnt vmcnt(0)
    s_mov_b64 s[60:61], exec
    v_cmp_eq_u32 vcc, s51, v44
    s_and_b64 s[60:61], s[60:61], vcc
    v_cmp_eq_u32 vcc, s52, v45
    s_and_b64 s[60:61], s[60:61], vcc
    v_cmp_eq_u32 vcc, s51, v46
    s_and_b64 s[60:61], s[60:61], vcc
    v_cmp_eq_u32 vcc, s52, v47
    s_and_b64 s[60:61], s[60:61], vcc
    v_cmp_eq_u32 vcc, s51, v48
    s_and_b64 s[60:61], s[60:61], vcc
    v_cmp_eq_u32 vcc, s52, v49
    s_and_b64 s[60:61], s[60:61], vcc
    v_cmp_eq_u32 vcc, s51, v50
    s_and_b64 s[60:61], s[60:61], vcc
    v_cmp_eq_u32 vcc, s52, v51
    s_and_b64 s[60:61], s[60:61], vcc
    s_cmp_eq_u64 s[60:61], exec
    s_cbranch_scc1 L_epok
    s_add_u32 s70, s70, 1
    s_cmp_lt_u32 s70, 131072
    s_cbranch_scc1 L_ep
L_epok:
    v_mov_b32 v40, 0
    v_mov_b32 v41, s51
    s_mov_b64 exec, 1
    buffer_store_dword v41, v40, s[36:39], 0 offen sc1
    s_mov_b64 exec, -1
L_noep:
    ds_read_b128 v[56:59], v29 offset:16
    s_waitcnt lgkmcnt(0)
L9:
    v_min3_u32 v56, v56, v57, v58
    v_min_u32 v56, v56, v59
    v_cmp_gt_u32 vcc, 1, v56
    s_cbranch_vccz L10
    s_sleep 4
    ds_read_b128 v[56:59], v29 offset:16
    s_waitcnt lgkmcnt(0)
    s_branch L9
L10:
    s_waitcnt vmcnt(5)
    s_add_u32 s92, s58, 0
    s_add_u32 m0, s62, 0
    s_nop 0
    buffer_load_dwordx4 v16, s[28:31], s92 offen lds
    s_waitcnt vmcnt(5)
    s_add_u32 s92, s58, 16384
    s_add_u32 m0, s62, 4096
    s_nop 0
    buffer_load_dwordx4 v16, s[28:31], s92 offen lds
    s_waitcnt vmcnt(5)
    s_add_u32 s92, s58, 32768
    s_add_u32 m0, s62, 8192
    s_nop 0
    buffer_load_dwordx4 v16, s[28:31], s92 offen lds
    s_waitcnt vmcnt(5)
    s_add_u32 s92, s58, 49152
    s_add_u32 m0, s62, 12288
    s_nop 0
    buffer_load_dwordx4 v16, s[28:31], s92 offen lds
    s_waitcnt vmcnt(5)
    s_add_u32 s92, s58, 65536
    s_add_u32 m0, s62, 16384
    s_nop 0
    buffer_load_dwordx4 v16, s[28:31], s92 offen lds
    s_waitcnt vmcnt(5)
    s_add_u32 s92, s58, 81920
    s_add_u32 m0, s62, 20480
    s_nop 0
    buffer_load_dwordx4 v16, s[28:31], s92 offen lds
    s_waitcnt vmcnt(5)
    s_add_u32 s92, s58, 98304
    s_add_u32 m0, s62, 24576
    s_nop 0
    buffer_load_dwordx4 v16, s[28:31], s92 offen lds
    s_waitcnt vmcnt(5)
    s_add_u32 s92, s58, 114688
    s_add_u32 m0, s62, 28672
    s_nop 0
    buffer_load_dwordx4 v16, s[28:31], s92 offen lds
    s_waitcnt vmcnt(5)
    s_add_u32 s92, s58, 131072
    s_add_u32 m0, s62, 32768
    s_nop 0
    buffer_load_dwordx4 v16, s[28:31], s92 offen lds
    s_waitcnt vmcnt(5)
    s_add_u32 s92, s58, 147456
    s_add_u32 m0, s62, 36864
    s_nop 0
    buffer_load_dwordx4 v16, s[28:31], s92 offen lds
    s_waitcnt vmcnt(5)
    s_add_u32 s92, s58, 163840
    s_add_u32 m0, s62, 40960
    s_nop 0
    buffer_load_dwordx4 v16, s[28:31], s92 offen lds
    s_waitcnt vmcnt(5)
    s_add_u32 s92, s58, 180224
    s_add_u32 m0, s62, 45056
    s_nop 0
    buffer_load_dwordx4 v16, s[28:31], s92 offen lds
    s_waitcnt vmcnt(5)
    s_add_u32 s92, s58, 196608
    s_add_u32 m0, s62, 49152
    s_nop 0
    buffer_load_dwordx4 v16, s[28:31], s92 offen lds
    s_waitcnt vmcnt(5)
    s_add_u32 s92, s58, 212992
    s_add_u32 m0, s62, 53248
    s_nop 0
    buffer_load_dwordx4 v16, s[28:31], s92 offen lds
    ds_read_b128 v[56:59], v29 offset:16
    s_waitcnt lgkmcnt(0)
L11:
    v_min3_u32 v56, v56, v57, v58
    v_min_u32 v56, v56, v59
    v_cmp_gt_u32 vcc, 2, v56
    s_cbranch_vccz L12
    s_sleep 4
    ds_read_b128 v[56:59], v29 offset:16
    s_waitcnt lgkmcnt(0)
    s_branch L11
L12:
    s_waitcnt vmcnt(5)
    s_add_u32 s92, s58, 229376
    s_add_u32 m0, s62, 57344
    s_nop 0
    buffer_load_dwordx4 v16, s[28:31], s92 offen lds
    s_waitcnt vmcnt(5)
    s_add_u32 s92, s58, 245760
    s_add_u32 m0, s62, 61440
    s_nop 0
    buffer_load_dwordx4 v16, s[28:31], s92 offen lds
    s_waitcnt vmcnt(5)
    s_add_u32 s92, s58, 262144
    s_add_u32 m0, s62, 65536
    s_nop 0
    buffer_load_dwordx4 v16, s[28:31], s92 offen lds
    s_waitcnt vmcnt(5)
    s_add_u32 s92, s58, 278528
    s_add_u32 m0, s62, 69632
    s_nop 0
    buffer_load_dwordx4 v16, s[28:31], s92 offen lds
    s_waitcnt vmcnt(5)
    s_add_u32 s92, s58, 294912
    s_add_u32 m0, s62, 73728
    s_nop 0
    buffer_load_dwordx4 v16, s[28:31], s92 offen lds
    s_waitcnt vmcnt(5)
    s_add_u32 s92, s58, 311296
    s_add_u32 m0, s62, 77824
    s_nop 0
    buffer_load_dwordx4 v16, s[28:31], s92 offen lds
    v_and_b32 v96, s73, v112
    v_lshlrev_b32 v97, 16, v112
    v_mul_f32 v96, s78, v96
    v_mul_f32 v97, s78, v97
    v_and_b32 v98, s73, v113
    v_lshlrev_b32 v99, 16, v113
    v_mul_f32 v98, s78, v98
    v_mul_f32 v99, s78, v99
    v_and_b32 v104, s73, v114
    v_lshlrev_b32 v105, 16, v114
    v_mul_f32 v104, s78, v104
    v_mul_f32 v105, s78, v105
    v_and_b32 v106, s73, v115
    v_lshlrev_b32 v107, 16, v115
    v_mul_f32 v106, s78, v106
    v_mul_f32 v107, s78, v107
    v_and_b32 v100, s73, v116
    v_lshlrev_b32 v101, 16, v116
    v_mul_f32 v100, s79, v100
    v_mul_f32 v101, s79, v101
    v_and_b32 v102, s73, v117
    v_lshlrev_b32 v103, 16, v117
    v_mul_f32 v102, s79, v102
    v_mul_f32 v103, s79, v103
    v_and_b32 v108, s73, v118
    v_lshlrev_b32 v109, 16, v118
    v_mul_f32 v108, s79, v108
    v_mul_f32 v109, s79, v109
    v_and_b32 v110, s73, v119
    v_lshlrev_b32 v111, 16, v119
    v_mul_f32 v110, s79, v110
    v_mul_f32 v111, s79, v111
    s_waitcnt vmcnt(5)
    s_add_u32 s92, s58, 327680
    s_add_u32 m0, s62, 81920
    s_nop 0
    buffer_load_dwordx4 v16, s[28:31], s92 offen lds
    s_waitcnt vmcnt(5)
    s_add_u32 s92, s58, 344064
    s_add_u32 m0, s62, 86016
    s_nop 0
    buffer_load_dwordx4 v16, s[28:31], s92 offen lds
    s_waitcnt vmcnt(5)
    s_add_u32 s92, s58, 360448
    s_add_u32 m0, s62, 90112
    s_nop 0
    buffer_load_dwordx4 v16, s[28:31], s92 offen lds
    s_waitcnt vmcnt(5)
    s_add_u32 s92, s58, 376832
    s_add_u32 m0, s62, 94208
    s_nop 0
    buffer_load_dwordx4 v16, s[28:31], s92 offen lds
    s_mov_b64 exec, 0x1ff
    buffer_load_dwordx2 v[20:21], v18, s[36:39], 0 offen sc1
    s_mov_b64 exec, -1
    s_waitcnt vmcnt(5)
    s_add_u32 s92, s58, 393216
    s_add_u32 m0, s62, 98304
    s_nop 0
    buffer_load_dwordx4 v16, s[28:31], s92 offen lds
    s_waitcnt vmcnt(5)
    s_add_u32 s92, s58, 409600
    s_add_u32 m0, s62, 102400
    s_nop 0
    buffer_load_dwordx4 v16, s[28:31], s92 offen lds
    s_waitcnt vmcnt(5)
    s_add_u32 s92, s58, 425984
    s_add_u32 m0, s62, 106496
    s_nop 0
    buffer_load_dwordx4 v16, s[28:31], s92 offen lds
    s_waitcnt vmcnt(5)
    s_add_u32 s92, s58, 442368
    s_add_u32 m0, s62, 110592
    s_nop 0
    buffer_load_dwordx4 v16, s[28:31], s92 offen lds
    s_mov_b32 s70, 0
    s_mov_b64 exec, 0x1ff
    s_waitcnt vmcnt(4)
L13:
    v_cmp_eq_u32 vcc, s51, v20
    v_cmp_eq_u32 s[68:69], s52, v21
    s_and_b64 vcc, vcc, s[68:69]
    s_cmp_eq_u64 vcc, exec
    s_cbranch_scc1 L14
    s_add_u32 s70, s70, 1
    s_cmp_gt_u32 s70, 131072
    s_cbranch_scc1 L14
    s_sleep 2
    buffer_load_dwordx2 v[20:21], v18, s[36:39], 0 offen sc1
    s_waitcnt vmcnt(0)
    s_branch L13
L14:
    s_mov_b64 exec, -1
    v_mov_b32 v255, 5
    s_mov_b64 exec, 1
    ds_write_b32 v30, v255
    s_mov_b64 exec, -1
    s_waitcnt vmcnt(0)
    v_mov_b32 v255, 6
    s_mov_b64 exec, 1
    ds_write_b32 v30, v255
    s_mov_b64 exec, -1
    ds_read_b128 v[56:59], v29 offset:16
    s_waitcnt lgkmcnt(0)
L15:
    v_min3_u32 v56, v56, v57, v58
    v_min_u32 v56, v56, v59
    v_cmp_gt_u32 vcc, 4, v56
    s_cbranch_vccz L16
    s_sleep 1
    ds_read_b128 v[56:59], v29 offset:16
    s_waitcnt lgkmcnt(0)
    s_branch L15
L16:
    s_setprio 2
    ds_read_b128 v[64:67], v246 offset:0
    ds_read_b128 v[68:71], v246 offset:8192
    ds_read_b128 v[72:75], v246 offset:16384
    ds_read_b128 v[76:79], v246 offset:24576
    ds_read_b128 v[80:83], v246 offset:1024
    ds_read_b128 v[84:87], v246 offset:9216
    ds_read_b128 v[88:91], v246 offset:17408
    ds_read_b128 v[92:95], v246 offset:25600
    s_waitcnt lgkmcnt(7)
    v_add_f32 v96, v96, v64
    v_add_f32 v97, v97, v65
    v_add_f32 v98, v98, v66
    v_add_f32 v99, v99, v67
    s_waitcnt lgkmcnt(5)
    v_add_f32 v100, v100, v72
    v_add_f32 v101, v101, v73
    v_add_f32 v102, v102, v74
    v_add_f32 v103, v103, v75
    v_add_f32 v96, v96, v68
    v_add_f32 v97, v97, v69
    v_add_f32 v98, v98, v70
    v_add_f32 v99, v99, v71
    s_waitcnt lgkmcnt(4)
    v_add_f32 v100, v100, v76
    v_add_f32 v101, v101, v77
    v_add_f32 v102, v102, v78
    v_add_f32 v103, v103, v79
    v_cvt_pk_bf16_f32 v64, v100, v100
    v_add_u32 v96, 0x10000, v96
    v_cvt_pk_bf16_f32 v65, v101, v101
    v_add_u32 v97, 0x10000, v97
    v_cvt_pk_bf16_f32 v66, v102, v102
    v_add_u32 v98, 0x10000, v98
    v_cvt_pk_bf16_f32 v67, v103, v103
    v_add_u32 v99, 0x10000, v99
    v_perm_b32 v64, v64, v96, s66
    v_perm_b32 v65, v65, v97, s66
    v_perm_b32 v66, v66, v98, s66
    v_perm_b32 v67, v67, v99, s66
    v_bfi_b32 v64, 1, v128, v64
    v_bfi_b32 v65, 1, v129, v65
    v_bfi_b32 v66, 1, v130, v66
    v_bfi_b32 v67, 1, v131, v67
    buffer_store_dwordx4 v[64:67], v247, s[36:39], s89 offen sc1
    s_waitcnt lgkmcnt(3)
    v_add_f32 v104, v104, v80
    v_add_f32 v105, v105, v81
    v_add_f32 v106, v106, v82
    v_add_f32 v107, v107, v83
    s_waitcnt lgkmcnt(1)
    v_add_f32 v108, v108, v88
    v_add_f32 v109, v109, v89
    v_add_f32 v110, v110, v90
    v_add_f32 v111, v111, v91
    v_add_f32 v104, v104, v84
    v_add_f32 v105, v105, v85
    v_add_f32 v106, v106, v86
    v_add_f32 v107, v107, v87
    s_waitcnt lgkmcnt(0)
    v_add_f32 v108, v108, v92
    v_add_f32 v109, v109, v93
    v_add_f32 v110, v110, v94
    v_add_f32 v111, v111, v95
    v_cvt_pk_bf16_f32 v80, v108, v108
    v_add_u32 v104, 0x10000, v104
    v_cvt_pk_bf16_f32 v81, v109, v109
    v_add_u32 v105, 0x10000, v105
    v_cvt_pk_bf16_f32 v82, v110, v110
    v_add_u32 v106, 0x10000, v106
    v_cvt_pk_bf16_f32 v83, v111, v111
    v_add_u32 v107, 0x10000, v107
    v_perm_b32 v80, v80, v104, s66
    v_perm_b32 v81, v81, v105, s66
    v_perm_b32 v82, v82, v106, s66
    v_perm_b32 v83, v83, v107, s66
    v_bfi_b32 v80, 1, v128, v80
    v_bfi_b32 v81, 1, v129, v81
    v_bfi_b32 v82, 1, v130, v82
    v_bfi_b32 v83, 1, v131, v83
    buffer_store_dwordx4 v[80:83], v247, s[36:39], s90 offen sc1
    v_mov_b32 v255, 7
    s_mov_b64 exec, 1
    ds_write_b32 v30, v255
    s_mov_b64 exec, -1
    s_setprio 0
    ds_read_b128 v[56:59], v29 offset:0
    s_waitcnt lgkmcnt(0)
L17:
    v_min3_u32 v56, v56, v57, v58
    v_min_u32 v56, v56, v59
    v_cmp_gt_u32 vcc, 7, v56
    s_cbranch_vccz L18
    ds_read_b128 v[56:59], v29 offset:0
    s_waitcnt lgkmcnt(0)
    s_branch L17
L18:
    ds_write_b128 v11, v[176:179] offset:53248
    ds_write_b128 v11, v[180:183] offset:57344
    ds_write_b128 v3, v[184:187] offset:0
    ds_write_b128 v3, v[188:191] offset:4096
    ds_write_b128 v3, v[192:195] offset:8192
    ds_write_b128 v3, v[196:199] offset:12288
    ds_write_b128 v3, v[200:203] offset:16384
    ds_write_b128 v3, v[204:207] offset:20480
    v_mov_b32 v255, 8
    s_waitcnt lgkmcnt(0)
    s_mov_b64 exec, 1
    ds_write_b32 v30, v255
    s_mov_b64 exec, -1
    ds_read_b128 v[56:59], v29 offset:16
    s_waitcnt lgkmcnt(0)
L19:
    v_min3_u32 v56, v56, v57, v58
    v_min_u32 v56, v56, v59
    v_cmp_gt_u32 vcc, 6, v56
    s_cbranch_vccz L20
    s_sleep 4
    ds_read_b128 v[56:59], v29 offset:16
    s_waitcnt lgkmcnt(0)
    s_branch L19
L20:
    ds_write_b128 v17, v[208:211] offset:0
    ds_write_b128 v17, v[212:215] offset:4096
    ds_write_b128 v17, v[216:219] offset:8192
    ds_write_b128 v17, v[220:223] offset:12288
    buffer_load_dwordx4 v[120:123], v2, s[36:39], s91 offen offset:0 sc1
    buffer_load_dwordx4 v[124:127], v2, s[36:39], s91 offen offset:1024 sc1
    ds_write_b128 v17, v[224:227] offset:16384
    ds_write_b128 v17, v[228:231] offset:20480
    ds_write_b128 v17, v[232:235] offset:24576
    v_mov_b32 v255, 9
    s_waitcnt lgkmcnt(0)
    s_mov_b64 exec, 1
    ds_write_b32 v30, v255
    s_mov_b64 exec, -1
    s_setprio 0
    s_mov_b32 s70, 0
    s_waitcnt vmcnt(0)
L21:
    v_xor_b32 v20, v120, v128
    v_bitop3_b32 v20, v20, v121, v129 bitop3:0xf6
    v_bitop3_b32 v20, v20, v122, v130 bitop3:0xf6
    v_bitop3_b32 v20, v20, v123, v131 bitop3:0xf6
    v_bitop3_b32 v20, v20, v124, v128 bitop3:0xf6
    v_bitop3_b32 v20, v20, v125, v129 bitop3:0xf6
    v_bitop3_b32 v20, v20, v126, v130 bitop3:0xf6
    v_bitop3_b32 v20, v20, v127, v131 bitop3:0xf6
    v_and_b32 v20, 1, v20
    v_cmp_ne_u32 vcc, 0, v20
    s_cbranch_vccz L22
    s_add_u32 s70, s70, 1
    s_cmp_gt_u32 s70, 0x20000
    s_cbranch_scc1 L22
    s_sleep 2
    buffer_load_dwordx4 v[120:123], v2, s[36:39], s91 offen offset:0 sc1
    buffer_load_dwordx4 v[124:127], v2, s[36:39], s91 offen offset:1024 sc1
    s_waitcnt vmcnt(0)
    s_branch L21
L22:
    s_setprio 2
    s_add_u32 s60, s74, 32768
    v_add_u32 v20, s60, v2
    v_and_b32 v120, -2, v120
    v_and_b32 v121, -2, v121
    v_and_b32 v122, -2, v122
    v_and_b32 v123, -2, v123
    v_and_b32 v124, -2, v124
    v_and_b32 v125, -2, v125
    v_and_b32 v126, -2, v126
    v_and_b32 v127, -2, v127
    ds_write_b128 v20, v[120:123] offset:0
    ds_write_b128 v20, v[124:127] offset:1024
    v_mov_b32 v255, 10
    s_waitcnt lgkmcnt(0)
    s_mov_b64 exec, 1
    ds_write_b32 v30, v255
    s_mov_b64 exec, -1
    s_waitcnt lgkmcnt(0)
    s_endpgm
L_end:
    s_endpgm
.section .rodata,"a"
.p2align 6
.amdhsa_kernel parallel_sum__ssm_conv_h3__dense_activation_silu__prompt_kernel
  .amdhsa_next_free_vgpr 256
  .amdhsa_next_free_sgpr 102
  .amdhsa_accum_offset 256
  .amdhsa_group_segment_fixed_size 0
  .amdhsa_kernarg_size 96
  .amdhsa_user_sgpr_count 2
  .amdhsa_user_sgpr_kernarg_segment_ptr 1
  .amdhsa_system_sgpr_workgroup_id_x 1
.end_amdhsa_kernel
```
